```python
import torch

def _softmax(x, axis=-1):
    return torch.softmax(x, dim=axis)

def _gelu(x):
    return torch.nn.functional.gelu(x, approximate='tanh')

def _silu(x):
    return torch.nn.functional.silu(x)

def _sigmoid(x):
    return torch.sigmoid(x)

def _layernorm(x, axis=-1, eps=1e-05):
    m = x.mean(dim=axis, keepdim=True)
    v = x.var(dim=axis, keepdim=True, unbiased=False)
    return (x - m) / torch.sqrt(v + eps)

def _scatter_add(tgt, idx, src, axis=0):
    return tgt.clone().index_add_(axis, idx, src)

def _segment_sum(src, seg, n):
    out = torch.zeros((n,) + src.shape[1:], dtype=src.dtype)
    return out.index_add_(0, seg, src)

def _pad(x, pw):
    flat = tuple((v for pair in reversed(pw) for v in pair))
    return torch.nn.functional.pad(x, flat)
kernel_name = 'adaLN_cond__spectral_gfnet__mixer_channel_mlp__prompt'

def setup_inputs():

    _w = lambda a: (lambda t: t.to(torch.bfloat16) if t.is_floating_point() else t)(torch.as_tensor(a))

    def _A_setup():
        B, S, D = (1, 2048, 640)
        Df = D // 2 + 1
        return {'x': _w((lambda *s: torch.randn(*s, dtype=torch.bfloat16) * 0.05)(B, S, D)), 'w_r': _w((lambda *s: torch.randn(*s, dtype=torch.bfloat16) * 3.2)(S, Df) * 0.02), 'w_i': _w((lambda *s: torch.randn(*s, dtype=torch.bfloat16) * 3.2)(S, Df) * 0.02)}
    _A_in = _A_setup()

    def _B_setup():
        B, S, D, F = (1, 2048, 640, 1536)
        return {'x': _w((lambda *s: torch.randn(*s, dtype=torch.bfloat16) * 0.05)(B, S, D)), 'w1': _w((lambda *s: torch.randn(*s, dtype=torch.bfloat16) * 1.6)(D, F) * D ** (-0.5)), 'b1': _w((lambda *s: torch.randn(*s, dtype=torch.bfloat16) * 0.4)(F)), 'w2': _w((lambda *s: torch.randn(*s, dtype=torch.bfloat16) * 0.1)(F, D) * F ** (-0.5)), 'b2': _w((lambda *s: torch.randn(*s, dtype=torch.bfloat16) * 0.1)(D))}
    _B_in = _B_setup()
    return {'A_x': _A_in['x'], 'A_w_r': _A_in['w_r'], 'A_w_i': _A_in['w_i'], 'B_x': _B_in['x'], 'B_w1': _B_in['w1'], 'B_b1': _B_in['b1'], 'B_w2': _B_in['w2'], 'B_b2': _B_in['b2'], 'c': _w((lambda *s: torch.randn(*s, dtype=torch.bfloat16) * 0.1)(1, 640) * 8.0), 'w_mod': _w((lambda *s: torch.randn(*s, dtype=torch.bfloat16) * 0.1)(640, 6 * 640) * 640 ** (-0.5) * 8.0)}

def reference(A_x, A_w_r, A_w_i, B_x, B_w1, B_b1, B_w2, B_b2, c, w_mod):

    def _A_ref(x, w_r, w_i):
        B, S, D = x.shape
        X = (lambda x, axes=(-2, -1): torch.fft.rfft2(x.float(), dim=axes))(x, axes=(-2, -1))
        W = w_r + 1j * w_i
        X = X * W
        y = (lambda x, s, axes=(-2, -1): torch.fft.irfft2(x, s=s, dim=axes).to(torch.bfloat16))(X, (S, D), axes=(-2, -1))
        return y

    def _B_ref(x, w1, b1, w2, b2):
        y = _layernorm(x, axis=-1)
        h = _gelu(torch.einsum('bsd,df->bsf', y, w1) + b1)
        return torch.einsum('bsf,fd->bsd', h, w2) + b2
    x = A_x
    mod = (_silu(c) @ w_mod).reshape(c.shape[0], 6, 1, -1)
    sa, ca, ga, sb, cb, gb = (mod[:, 0].clone(), mod[:, 1].clone(), mod[:, 2].clone(), mod[:, 3].clone(), mod[:, 4].clone(), mod[:, 5].clone())
    h = _layernorm(x, axis=-1) * (1 + ca) + sa
    x = x + ga * _A_ref(h, A_w_r, A_w_i)
    h = _layernorm(x, axis=-1) * (1 + cb) + sb
    x = x + gb * _B_ref(h, B_w1, B_b1, B_w2, B_b2)
    return x
```

```asm
; @launch grid=(256,1,1) block=(256,1,1) lds=163840
.amdgcn_target "amdgcn-amd-amdhsa--gfx950"
.text
.globl adaLN_cond__spectral_gfnet__mixer_channel_mlp__prompt_kernel
.p2align 8
.type adaLN_cond__spectral_gfnet__mixer_channel_mlp__prompt_kernel,@function
adaLN_cond__spectral_gfnet__mixer_channel_mlp__prompt_kernel:
    s_cmp_ge_u32 s2, 256
    s_cbranch_scc1 L_end
    s_load_dwordx2 s[36:37], s[0:1], 72
    s_load_dwordx2 s[32:33], s[0:1], 64
    s_load_dwordx16 s[64:79], s[0:1], 0
    s_load_dwordx2 s[44:45], s[0:1], 96
    s_lshr_b32 s52, s2, 3
    s_getpc_b64 s[58:59]
L_pc:
    v_and_b32 v12, 7, v0
    v_lshl_add_u32 v12, v12, 5, s52
    v_lshlrev_b32 v12, 7, v12
    v_min_u32 v12, L_last-L_pc, v12
    v_mov_b32 v13, s59
    v_add_co_u32 v12, vcc, s58, v12
    s_nop 1
    v_addc_co_u32 v13, vcc, 0, v13, vcc
    global_load_dword v250, v[12:13], off
    v_lshrrev_b32 v8, 6, v0
    v_and_b32 v1, 63, v0
    v_readfirstlane_b32 s49, v8
    s_mov_b32 s35, 0x00020000
    s_movk_i32 s34, 1280
    s_mov_b32 s39, s35
    s_mov_b32 s38, 4915200
    s_mov_b32 s7, s35
    s_mov_b32 s6, 2621440
    s_and_b32 s57, s2, 3
    s_andn2_b32 s56, s2, 3
    s_add_u32 s56, s56, s49
    s_mul_i32 s58, s57, 38400
    s_add_u32 s58, s58, s56
    s_lshl_b32 s58, s58, 5
    s_mul_i32 s60, s57, 320
    v_lshrrev_b32 v8, 1, v1
    v_lshlrev_b32 v9, 1, v8
    v_lshlrev_b32 v11, 3, v8
    v_mul_u32_u24 v8, 7680, v8
    v_and_b32 v10, 1, v0
    v_lshlrev_b32 v10, 4, v10
    v_lshl_add_u32 v236, v8, 2, v10
    v_add_u32 v238, v8, v10
    s_and_b32 s51, s2, 7
    s_lshl_b32 s48, s51, 5
    s_or_b32 s48, s48, s52
    s_lshl_b32 s62, s49, 9
    s_add_u32 s62, s62, s48
    s_mulk_i32 s62, 1280
    s_add_u32 s63, s62, 327680
    v_and_b32 v2, 31, v0
    v_lshrrev_b32 v3, 5, v1
    v_lshlrev_b32 v6, 4, v1
    v_lshlrev_b32 v15, 2, v3
    v_lshl_add_u32 v15, v2, 3, v15
    s_waitcnt lgkmcnt(0)
    buffer_load_dwordx2 v[190:191], v11, s[32:35], s60 offen
    buffer_load_ushort v192, v9, s[32:35], s60 offen offset:256
    buffer_load_dwordx4 v[32:35], v236, s[36:39], s58 offen
    s_add_u32 s58, s58, 7680
    buffer_load_dwordx4 v[36:39], v236, s[36:39], s58 offen
    s_add_u32 s58, s58, 7680
    buffer_load_dwordx4 v[40:43], v236, s[36:39], s58 offen
    s_add_u32 s58, s58, 7680
    buffer_load_dwordx4 v[44:47], v236, s[36:39], s58 offen
    s_add_u32 s58, s58, 960000
    buffer_load_dwordx4 v[48:51], v238, s[36:39], s58 offen
    s_mov_b64 s[4:5], s[64:65]
    s_load_dword s50, s[44:45], 0
    buffer_load_dwordx4 v[60:63], v6, s[4:7], s62 offen
    buffer_load_dwordx4 v[64:67], v6, s[4:7], s63 offen
    buffer_load_dword v68, v15, s[4:7], s62 offen offset:1024
    buffer_load_dword v69, v15, s[4:7], s63 offen offset:1024
L_tight:
    s_load_dwordx2 s[40:41], s[0:1], 80
    s_mov_b32 s3, 0xffff0000
    s_mul_i32 s57, s57, 15360
    s_lshl_b32 s59, s56, 6
    s_add_u32 s61, s57, s59
    s_mov_b32 s96, 200000
    v_and_b32 v4, 15, v0
    v_lshrrev_b32 v5, 4, v1
    v_lshlrev_b32 v7, 4, v0
    s_mov_b64 s[24:25], s[76:77]
    s_mov_b64 s[16:17], s[72:73]
    s_mov_b64 s[8:9], s[66:67]
    s_mov_b64 s[12:13], s[68:69]
    s_mov_b64 s[20:21], s[74:75]
    s_mov_b64 s[28:29], s[78:79]
    s_mov_b32 s26, 1966080
    s_mov_b32 s27, s35
    s_mov_b32 s18, 1966080
    s_mov_b32 s19, s35
    s_mov_b32 s46, 268435456
    s_mov_b32 s47, s35
    s_mov_b32 s10, 1314816
    s_mov_b32 s11, s35
    s_mov_b32 s14, 1314816
    s_mov_b32 s15, s35
    s_add_u32 s61, s61, 65536
    s_cmp_lt_u32 s2, 240
    s_cselect_b32 s68, s61, 2146435072
    s_sub_u32 s56, 8, s51
    s_and_b32 s56, s56, 7
    s_cmp_lt_u32 s52, 16
    s_cselect_b32 s53, s51, s56
    s_mul_i32 s85, s49, 30720
    s_lshr_b32 s54, s48, 4
    s_and_b32 s55, s48, 15
    s_and_b32 s61, s55, 14
    s_lshr_b32 s62, 21905, s61
    s_and_b32 s62, s62, 3
    s_mul_i32 s61, s61, 3
    s_and_b32 s63, s55, 1
    s_lshl_b32 s89, s62, 1
    s_add_u32 s89, s89, s61
    s_add_u32 s89, s89, s63
    s_lshl_b32 s63, s63, 1
    s_cmp_eq_u32 s62, s63
    s_cselect_b32 s63, 1, s63
    s_lshl_b32 s63, s63, 1
    s_add_u32 s88, s61, s63
    s_mul_i32 s56, s48, 205
    s_lshr_b32 s56, s56, 10
    s_mul_i32 s57, s56, 5
    s_sub_u32 s57, s48, s57
    s_lshl_b32 s57, s57, 2
    s_add_u32 s57, s57, s49
    s_mul_i32 s58, s56, 40960
    s_lshl_b32 s59, s57, 11
    s_add_u32 s69, s58, s59
    s_add_u32 s69, s69, 21233664
    s_mul_i32 s58, s56, 171
    s_lshr_b32 s58, s58, 9
    s_mul_i32 s59, s58, 3
    s_sub_u32 s56, s56, s59
    s_and_b32 s61, s58, 14
    s_lshr_b32 s62, 21905, s61
    s_and_b32 s62, s62, 3
    s_mul_i32 s61, s61, 3
    s_and_b32 s63, s58, 1
    s_lshl_b32 s60, s62, 1
    s_add_u32 s60, s60, s61
    s_add_u32 s60, s60, s63
    s_lshl_b32 s63, s63, 1
    s_cmp_eq_u32 s62, s63
    s_cselect_b32 s63, 1, s63
    s_lshl_b32 s63, s63, 1
    s_add_u32 s59, s61, s63
    s_add_u32 s59, s59, s56
    s_cmp_lt_u32 s56, 2
    s_cselect_b32 s59, s59, s60
    s_mul_i32 s59, s59, 40960
    s_lshl_b32 s57, s57, 6
    s_add_u32 s84, s59, s57
    s_cmp_lt_u32 s48, 240
    s_cselect_b32 s69, s69, 2146435072
    s_cselect_b32 s84, s84, 1073217536
    s_sub_u32 s56, 30, s52
    s_lshl_b32 s56, s56, 2
    s_add_u32 s56, s56, s51
    s_bitcmp1_b32 s52, 0
    s_cselect_b32 s56, 255, s56
    s_and_b32 s57, s56, 3
    s_lshl_b32 s57, s57, 2
    s_add_u32 s57, s57, s49
    s_lshr_b32 s56, s56, 2
    s_and_b32 s61, s57, 14
    s_lshr_b32 s62, 21905, s61
    s_and_b32 s62, s62, 3
    s_mul_i32 s61, s61, 3
    s_and_b32 s63, s57, 1
    s_lshl_b32 s60, s62, 1
    s_add_u32 s60, s60, s61
    s_add_u32 s60, s60, s63
    s_lshl_b32 s63, s63, 1
    s_cmp_eq_u32 s62, s63
    s_cselect_b32 s63, 1, s63
    s_lshl_b32 s63, s63, 1
    s_add_u32 s59, s61, s63
    s_mul_i32 s58, s56, 98304
    s_lshl_b32 s60, s60, 6
    s_add_u32 s87, s58, s60
    s_mul_i32 s57, s57, 20
    s_add_u32 s57, s57, s56
    s_lshl_b32 s57, s57, 11
    s_add_u32 s86, s57, 18874368
    s_cmp_lt_u32 s56, 20
    s_cselect_b32 s86, s86, 2146435072
    v_lshrrev_b32 v8, 2, v1
    v_and_b32 v9, 3, v1
    v_lshlrev_b32 v9, 4, v9
    v_mul_u32_u24 v10, 1280, v8
    v_add_u32 v252, v9, v10
    v_mul_u32_u24 v10, 3072, v8
    v_add_u32 v251, v9, v10
    v_lshrrev_b32 v96, 2, v1
    v_lshlrev_b32 v96, 6, v96
    v_and_b32 v99, 3, v1
    v_lshl_add_u32 v96, v99, 3, v96
    v_add_u32 v242, s85, v96
    v_lshl_add_u32 v99, v5, 8, v242
    s_add_u32 m0, s85, 20480
    s_nop 0
    buffer_load_dwordx4 v251, s[16:19], s87 offen lds
    s_add_u32 m0, s85, 21504
    s_add_u32 s87, s87, 49152
    buffer_load_dwordx4 v251, s[16:19], s87 offen lds
    s_add_u32 m0, s85, 22528
    s_nop 0
    buffer_load_dwordx4 v252, s[24:27], s84 offen lds
    s_add_u32 m0, s85, 23552
    s_add_u32 s84, s84, 20480
    buffer_load_dwordx4 v252, s[24:27], s84 offen lds
    s_mul_i32 s56, s52, 20
    s_sub_u32 s57, 623, s56
    s_mul_i32 s59, s49, 5
    s_sub_u32 s60, 15, s59
    s_cmp_lt_u32 s52, 16
    s_cselect_b32 s56, s56, s57
    s_cselect_b32 s58, 1, -1
    s_cselect_b32 s59, s59, s60
    s_add_u32 s60, s56, s53
    s_and_b32 s60, s60, 1
    s_add_u32 s70, s59, s60
    s_sub_u32 s56, s56, s60
    s_lshl_b32 s61, s49, 9
    s_add_u32 s61, s61, s53
    s_movk_i32 s62, 321
    v_add_u32 v8, 0, v1
    v_mul_u32_u24 v9, 171, v8
    v_lshrrev_b32 v9, 9, v9
    v_mad_i32_i24 v10, v9, -3, v8
    v_lshl_add_u32 v9, v9, 3, s61
    v_mul_i32_i24 v9, s58, v9
    v_and_b32 v9, 2047, v9
    v_lshl_add_u32 v10, v10, 3, s56
    v_mad_u32_u24 v9, v9, s62, v10
    v_lshlrev_b32 v196, 1, v9
    v_add_u32 v8, 64, v1
    v_mul_u32_u24 v9, 171, v8
    v_lshrrev_b32 v9, 9, v9
    v_mad_i32_i24 v10, v9, -3, v8
    v_lshl_add_u32 v9, v9, 3, s61
    v_mul_i32_i24 v9, s58, v9
    v_and_b32 v9, 2047, v9
    v_lshl_add_u32 v10, v10, 3, s56
    v_mad_u32_u24 v9, v9, s62, v10
    v_lshlrev_b32 v197, 1, v9
    v_add_u32 v8, 128, v1
    v_mul_u32_u24 v9, 171, v8
    v_lshrrev_b32 v9, 9, v9
    v_mad_i32_i24 v10, v9, -3, v8
    v_lshl_add_u32 v9, v9, 3, s61
    v_mul_i32_i24 v9, s58, v9
    v_and_b32 v9, 2047, v9
    v_lshl_add_u32 v10, v10, 3, s56
    v_mad_u32_u24 v9, v9, s62, v10
    v_lshlrev_b32 v198, 1, v9
    v_lshrrev_b32 v8, 3, v1
    v_and_b32 v9, 2, v8
    v_and_b32 v10, 7, v1
    v_xor_b32 v9, v9, v10
    v_mul_u32_u24 v8, 3072, v8
    v_lshl_add_u32 v240, v9, 4, v8
    v_xor_b32 v241, 64, v240
    v_add_u32 v241, 24576, v241
    s_mul_i32 s90, s49, 491520
    s_lshl_b32 s57, s88, 6
    s_add_u32 s90, s90, s57
    s_waitcnt vmcnt(14)
    v_lshlrev_b32 v188, 16, v190
    v_and_b32 v189, s3, v190
    v_lshlrev_b32 v190, 16, v191
    v_and_b32 v191, s3, v191
    s_waitcnt vmcnt(13)
    v_lshlrev_b32 v192, 16, v192
    v_mul_f32 v8, 0xbfb8aa3b, v188
    v_mul_f32 v9, 0xbfb8aa3b, v189
    v_mul_f32 v10, 0xbfb8aa3b, v190
    v_mul_f32 v11, 0xbfb8aa3b, v191
    v_mul_f32 v12, 0xbfb8aa3b, v192
    v_exp_f32 v8, v8
    v_exp_f32 v9, v9
    v_exp_f32 v10, v10
    v_exp_f32 v11, v11
    v_exp_f32 v12, v12
    v_add_f32 v8, 1.0, v8
    v_add_f32 v9, 1.0, v9
    v_add_f32 v10, 1.0, v10
    v_add_f32 v11, 1.0, v11
    v_add_f32 v12, 1.0, v12
    v_rcp_f32 v8, v8
    v_rcp_f32 v9, v9
    v_rcp_f32 v10, v10
    v_rcp_f32 v11, v11
    v_rcp_f32 v12, v12
    v_mul_f32 v8, v188, v8
    v_mul_f32 v9, v189, v9
    v_mul_f32 v10, v190, v10
    v_mul_f32 v11, v191, v11
    v_mul_f32 v12, v192, v12
    v_cvt_pk_bf16_f32 v8, v8, v8
    v_cvt_pk_bf16_f32 v9, v9, v9
    v_cvt_pk_bf16_f32 v10, v10, v10
    v_cvt_pk_bf16_f32 v11, v11, v11
    v_cvt_pk_bf16_f32 v12, v12, v12
    v_lshlrev_b32 v188, 16, v8
    v_lshlrev_b32 v189, 16, v9
    v_lshlrev_b32 v190, 16, v10
    v_lshlrev_b32 v191, 16, v11
    v_lshlrev_b32 v192, 16, v12
    s_waitcnt lgkmcnt(0)
    s_mul_i32 s50, s50, 0x9E3779B1
    s_add_u32 s50, s50, 0x7F4A7C15
    s_or_b32 s50, s50, 0xffc00000
    s_bfe_u32 s72, s50, 524288
    s_bfe_u32 s73, s50, 524296
    s_bfe_u32 s74, s50, 524304
    s_bfe_u32 s75, s50, 524312
    v_and_b32 v13, 1, v1
    v_lshlrev_b32 v13, 5, v13
    v_lshl_add_u32 v13, v3, 4, v13
    v_mov_b32 v14, 2146435072
    v_cmp_gt_u32 vcc, 2, v2
    s_nop 1
    v_cndmask_b32_e64 v194, v14, v13, vcc
    v_mov_b32 v195, 0xffffff00
    s_lshl_b32 s56, s49, 8
    s_add_u32 s56, s56, 4096
    s_mov_b32 s57, 147456
    v_lshl_add_u32 v12, v4, 4, s56
    v_mul_u32_u24 v13, 15360, v5
    v_add_u32 v200, v12, v13
    v_lshrrev_b32 v12, 2, v12
    v_and_b32 v13, 1, v5
    v_lshl_add_u32 v13, v13, 1, v3
    v_mul_u32_u24 v13, 1280, v13
    v_add3_u32 v201, v12, v13, s57
    v_lshl_add_u32 v202, v0, 2, s57
    v_cmp_lt_u32 vcc, 159, v0
    s_nop 1
    v_cndmask_b32_e64 v204, 0, 1.0, vcc
    v_lshl_add_u32 v12, v2, 2, s49
    v_mul_u32_u24 v13, 3, v12
    s_mul_i32 s56, s49, 1280
    s_add_u32 s56, s56, s57
    v_lshl_add_u32 v12, v2, 2, s56
    v_lshl_add_u32 v14, v3, 1, v13
    v_add_u32 v15, 0, v14
    v_mul_u32_u24 v16, 205, v15
    v_lshrrev_b32 v16, 10, v16
    v_mad_i32_i24 v15, v16, -5, v15
    v_lshl_add_u32 v205, v15, 7, v12
    v_add_u32 v15, 4, v14
    v_mul_u32_u24 v16, 205, v15
    v_lshrrev_b32 v16, 10, v16
    v_mad_i32_i24 v15, v16, -5, v15
    v_lshl_add_u32 v206, v15, 7, v12
    v_add_u32 v15, 8, v13
    v_mul_u32_u24 v16, 205, v15
    v_lshrrev_b32 v16, 10, v16
    v_mad_i32_i24 v15, v16, -5, v15
    v_lshl_add_u32 v207, v15, 7, v12
    s_mov_b32 s76, 65536
    s_mov_b32 s77, 80896
    s_mov_b32 s78, 96256
    s_mov_b32 s79, 111616
    s_and_b32 s56, s55, 7
    s_mul_i32 s56, s56, 320
    v_mov_b32 v8, s56
    v_cmp_lt_u32 vcc, 223, v0
    s_nop 1
    v_cndmask_b32_e64 v8, 0, v8, vcc
    v_min_u32 v9, 3888, v7
    v_add_u32 v8, v8, v9
    v_add_u32 v246, 4096, v8
    s_lshr_b32 s56, s56, 1
    v_lshl_add_u32 v245, v2, 3, s56
    s_lshl_b32 s56, s88, 6
    s_lshl_b32 s57, s89, 6
    v_mov_b32 v8, s56
    v_mov_b32 v9, s57
    v_cmp_gt_u32 vcc, 16, v2
    s_nop 1
    v_cndmask_b32_e64 v8, v9, v8, vcc
    v_lshl_add_u32 v244, v4, 3, v8
    s_mov_b32 s22, 3072
    s_mov_b32 s23, s35
    s_mov_b32 s30, 1280
    s_mov_b32 s31, s35
    s_mov_b32 s42, 2621440
    s_mov_b32 s43, s35
    s_getreg_b32 s94, hwreg(HW_REG_XCC_ID, 0, 4)
    s_lshl_b32 s56, s48, 2
    s_add_u32 s56, s56, 1024
    v_mov_b32 v8, s94
    v_cmp_eq_u32 vcc, 0, v0
    v_mov_b32 v9, 2146435072
    s_nop 0
    v_cndmask_b32_e64 v9, v9, v0, vcc
    buffer_store_dword v8, v9, s[44:47], s56 offen sc1
    s_waitcnt vmcnt(13)
    v_lshlrev_b32 v8, 16, v32
    v_and_b32 v9, s3, v32
    v_pk_mul_f32 v[52:53], v[8:9], v[188:189] op_sel:[0,0] op_sel_hi:[1,0]
    v_lshlrev_b32 v10, 16, v33
    v_and_b32 v11, s3, v33
    v_pk_mul_f32 v[54:55], v[10:11], v[188:189] op_sel:[0,0] op_sel_hi:[1,0]
    v_lshlrev_b32 v8, 16, v34
    v_and_b32 v9, s3, v34
    v_pk_mul_f32 v[56:57], v[8:9], v[188:189] op_sel:[0,0] op_sel_hi:[1,0]
    v_lshlrev_b32 v10, 16, v35
    v_and_b32 v11, s3, v35
    v_pk_mul_f32 v[58:59], v[10:11], v[188:189] op_sel:[0,0] op_sel_hi:[1,0]
    s_waitcnt vmcnt(12)
    v_lshlrev_b32 v8, 16, v36
    v_and_b32 v9, s3, v36
    v_pk_fma_f32 v[52:53], v[8:9], v[188:189], v[52:53] op_sel:[0,1,0] op_sel_hi:[1,1,1]
    v_lshlrev_b32 v10, 16, v37
    v_and_b32 v11, s3, v37
    v_pk_fma_f32 v[54:55], v[10:11], v[188:189], v[54:55] op_sel:[0,1,0] op_sel_hi:[1,1,1]
    v_lshlrev_b32 v8, 16, v38
    v_and_b32 v9, s3, v38
    v_pk_fma_f32 v[56:57], v[8:9], v[188:189], v[56:57] op_sel:[0,1,0] op_sel_hi:[1,1,1]
    v_lshlrev_b32 v10, 16, v39
    v_and_b32 v11, s3, v39
    v_pk_fma_f32 v[58:59], v[10:11], v[188:189], v[58:59] op_sel:[0,1,0] op_sel_hi:[1,1,1]
    s_waitcnt vmcnt(11)
    v_lshlrev_b32 v8, 16, v40
    v_and_b32 v9, s3, v40
    v_pk_fma_f32 v[52:53], v[8:9], v[190:191], v[52:53] op_sel:[0,0,0] op_sel_hi:[1,0,1]
    v_lshlrev_b32 v10, 16, v41
    v_and_b32 v11, s3, v41
    v_pk_fma_f32 v[54:55], v[10:11], v[190:191], v[54:55] op_sel:[0,0,0] op_sel_hi:[1,0,1]
    v_lshlrev_b32 v8, 16, v42
    v_and_b32 v9, s3, v42
    v_pk_fma_f32 v[56:57], v[8:9], v[190:191], v[56:57] op_sel:[0,0,0] op_sel_hi:[1,0,1]
    v_lshlrev_b32 v10, 16, v43
    v_and_b32 v11, s3, v43
    v_pk_fma_f32 v[58:59], v[10:11], v[190:191], v[58:59] op_sel:[0,0,0] op_sel_hi:[1,0,1]
    s_waitcnt vmcnt(10)
    v_lshlrev_b32 v8, 16, v44
    v_and_b32 v9, s3, v44
    v_pk_fma_f32 v[52:53], v[8:9], v[190:191], v[52:53] op_sel:[0,1,0] op_sel_hi:[1,1,1]
    v_lshlrev_b32 v10, 16, v45
    v_and_b32 v11, s3, v45
    v_pk_fma_f32 v[54:55], v[10:11], v[190:191], v[54:55] op_sel:[0,1,0] op_sel_hi:[1,1,1]
    v_lshlrev_b32 v8, 16, v46
    v_and_b32 v9, s3, v46
    v_pk_fma_f32 v[56:57], v[8:9], v[190:191], v[56:57] op_sel:[0,1,0] op_sel_hi:[1,1,1]
    v_lshlrev_b32 v10, 16, v47
    v_and_b32 v11, s3, v47
    v_pk_fma_f32 v[58:59], v[10:11], v[190:191], v[58:59] op_sel:[0,1,0] op_sel_hi:[1,1,1]
    s_waitcnt vmcnt(9)
    v_lshlrev_b32 v8, 16, v48
    v_and_b32 v9, s3, v48
    v_pk_fma_f32 v[52:53], v[8:9], v[192:193], v[52:53] op_sel:[0,0,0] op_sel_hi:[1,0,1]
    v_lshlrev_b32 v10, 16, v49
    v_and_b32 v11, s3, v49
    v_pk_fma_f32 v[54:55], v[10:11], v[192:193], v[54:55] op_sel:[0,0,0] op_sel_hi:[1,0,1]
    v_lshlrev_b32 v8, 16, v50
    v_and_b32 v9, s3, v50
    v_pk_fma_f32 v[56:57], v[8:9], v[192:193], v[56:57] op_sel:[0,0,0] op_sel_hi:[1,0,1]
    v_lshlrev_b32 v10, 16, v51
    v_and_b32 v11, s3, v51
    v_pk_fma_f32 v[58:59], v[10:11], v[192:193], v[58:59] op_sel:[0,0,0] op_sel_hi:[1,0,1]
    v_permlane32_swap_b32 v52, v56
    v_permlane32_swap_b32 v53, v57
    v_permlane32_swap_b32 v54, v58
    v_permlane32_swap_b32 v55, v59
    v_pk_add_f32 v[52:53], v[52:53], v[56:57]
    v_pk_add_f32 v[54:55], v[54:55], v[58:59]
    s_nop 0
    v_permlane16_swap_b32 v52, v53
    v_permlane16_swap_b32 v54, v55
    v_add_f32 v52, v52, v53
    v_add_f32 v54, v54, v55
    s_nop 0
    v_add_f32_dpp v52, v52, v52 row_ror:8 row_mask:0xf bank_mask:0xf
    v_add_f32_dpp v54, v54, v54 row_ror:8 row_mask:0xf bank_mask:0xf
    s_nop 0
    v_add_f32_dpp v52, v52, v52 row_ror:4 row_mask:0xf bank_mask:0xf
    v_add_f32_dpp v54, v54, v54 row_ror:4 row_mask:0xf bank_mask:0xf
    s_nop 0
    v_add_f32_dpp v53, v52, v52 row_ror:2 row_mask:0xf bank_mask:0xf
    v_add_f32_dpp v55, v54, v54 row_ror:2 row_mask:0xf bank_mask:0xf
    v_add_f32_dpp v52, v52, v52 row_ror:2 row_mask:0xf bank_mask:0xf
    v_add_f32_dpp v54, v54, v54 row_ror:2 row_mask:0xf bank_mask:0xf
    s_nop 0
    v_permlane16_swap_b32 v52, v53
    v_permlane16_swap_b32 v54, v55
    v_and_or_b32 v52, v52, v195, s72
    v_and_or_b32 v53, v53, v195, s73
    v_and_or_b32 v54, v54, v195, s74
    v_and_or_b32 v55, v55, v195, s75
    buffer_store_dwordx4 v[52:55], v194, s[44:47], s68 offen sc1
    s_lshl_b32 s92, s54, 2
    s_add_u32 s92, s92, s49
    s_mul_i32 s92, s92, 480
    s_add_u32 s92, s92, s88
    s_lshl_b32 s92, s92, 6
    v_min_u32 v247, 9, v1
    v_mul_u32_u24 v247, 3072, v247
    buffer_load_dword v243, v247, s[16:19], s92 offen
    s_lshl_b32 s56, s52, 2
    s_add_u32 s56, s56, s49
    s_lshl_b32 s56, s56, 4
    s_add_u32 s56, s56, s51
    s_mul_i32 s56, s56, 642
    s_and_b32 s56, s56, -4
    v_min_u32 v8, 5, v2
    v_lshlrev_b32 v8, 7, v8
    v_mul_u32_u24 v9, 5136, v3
    v_add_u32 v8, v8, v9
    buffer_load_dword v248, v8, s[8:11], s56 offen
    buffer_load_dword v249, v8, s[12:15], s56 offen
    s_waitcnt vmcnt(5)
    ds_read_b64_tr_b16 a[0:1], v99 offset:20480
    ds_read_b64_tr_b16 a[2:3], v99 offset:20736
    ds_read_b64_tr_b16 a[4:5], v99 offset:20512
    ds_read_b64_tr_b16 a[6:7], v99 offset:20768
    ds_read_b64_tr_b16 a[8:9], v242 offset:22528
    ds_read_b64_tr_b16 a[10:11], v242 offset:23552
    ds_read_b64_tr_b16 a[12:13], v242 offset:22560
    ds_read_b64_tr_b16 a[14:15], v242 offset:23584
    v_mul_u32_u24 v8, 3, v1
    v_lshl_add_u32 v9, v4, 4, s85
    v_add_u32 v10, 0, v8
    v_mul_u32_u24 v11, 205, v10
    v_lshrrev_b32 v11, 10, v11
    v_mad_i32_i24 v10, v11, -5, v10
    v_lshl_add_u32 v92, v10, 10, v9
    v_add_u32 v10, 1, v8
    v_mul_u32_u24 v11, 205, v10
    v_lshrrev_b32 v11, 10, v11
    v_mad_i32_i24 v10, v11, -5, v10
    s_waitcnt lgkmcnt(6)
    buffer_store_dwordx4 a[0:3], v6, s[44:47], s86 offen offset:0 sc1
    v_lshl_add_u32 v93, v10, 10, v9
    v_add_u32 v10, 2, v8
    v_mul_u32_u24 v11, 205, v10
    v_lshrrev_b32 v11, 10, v11
    v_mad_i32_i24 v10, v11, -5, v10
    v_lshl_add_u32 v94, v10, 10, v9
    v_add_u32 v10, 3, v8
    v_mul_u32_u24 v11, 205, v10
    v_lshrrev_b32 v11, 10, v11
    v_mad_i32_i24 v10, v11, -5, v10
    v_lshl_add_u32 v95, v10, 10, v9
    v_add_u32 v10, 4, v8
    v_mul_u32_u24 v11, 205, v10
    v_lshrrev_b32 v11, 10, v11
    v_mad_i32_i24 v10, v11, -5, v10
    v_lshl_add_u32 v96, v10, 10, v9
    v_lshl_add_u32 v9, v2, 3, s85
    v_lshl_add_u32 v9, v3, 9, v9
    v_lshl_add_u32 v8, v2, 1, v3
    v_lshl_add_u32 v10, v8, 1, 2
    v_mul_u32_u24 v11, 205, v10
    v_lshrrev_b32 v11, 10, v11
    v_mad_i32_i24 v10, v11, -5, v10
    v_lshl_add_u32 v97, v10, 10, v9
    v_lshl_add_u32 v10, v8, 1, 3
    v_mul_u32_u24 v11, 205, v10
    v_lshrrev_b32 v11, 10, v11
    v_mad_i32_i24 v10, v11, -5, v10
    v_lshl_add_u32 v98, v10, 10, v9
    v_lshlrev_b32 v72, 16, v60
    v_and_b32 v74, s3, v60
    v_lshlrev_b32 v76, 16, v61
    v_and_b32 v78, s3, v61
    s_waitcnt lgkmcnt(4)
    buffer_store_dwordx4 a[4:7], v6, s[44:47], s86 offen offset:1024 sc1
    v_lshlrev_b32 v80, 16, v62
    v_and_b32 v82, s3, v62
    v_lshlrev_b32 v84, 16, v63
    v_and_b32 v86, s3, v63
    v_lshlrev_b32 v88, 16, v68
    v_and_b32 v90, s3, v68
    v_lshlrev_b32 v73, 16, v64
    v_and_b32 v75, s3, v64
    v_lshlrev_b32 v77, 16, v65
    v_and_b32 v79, s3, v65
    v_lshlrev_b32 v81, 16, v66
    v_and_b32 v83, s3, v66
    v_lshlrev_b32 v85, 16, v67
    v_and_b32 v87, s3, v67
    v_lshlrev_b32 v89, 16, v69
    v_and_b32 v91, s3, v69
    v_pk_add_f32 v[8:9], v[72:73], v[74:75]
    v_pk_mul_f32 v[10:11], v[72:73], v[72:73]
    v_pk_fma_f32 v[10:11], v[74:75], v[74:75], v[10:11]
    v_pk_add_f32 v[8:9], v[8:9], v[76:77]
    v_pk_fma_f32 v[10:11], v[76:77], v[76:77], v[10:11]
    v_pk_add_f32 v[8:9], v[8:9], v[78:79]
    v_pk_fma_f32 v[10:11], v[78:79], v[78:79], v[10:11]
    v_pk_add_f32 v[8:9], v[8:9], v[80:81]
    v_pk_fma_f32 v[10:11], v[80:81], v[80:81], v[10:11]
    v_pk_add_f32 v[8:9], v[8:9], v[82:83]
    v_pk_fma_f32 v[10:11], v[82:83], v[82:83], v[10:11]
    v_pk_add_f32 v[8:9], v[8:9], v[84:85]
    v_pk_fma_f32 v[10:11], v[84:85], v[84:85], v[10:11]
    v_pk_add_f32 v[8:9], v[8:9], v[86:87]
    v_pk_fma_f32 v[10:11], v[86:87], v[86:87], v[10:11]
    v_pk_add_f32 v[8:9], v[8:9], v[88:89]
    v_pk_fma_f32 v[10:11], v[88:89], v[88:89], v[10:11]
    s_waitcnt lgkmcnt(2)
    buffer_store_dwordx4 a[8:11], v6, s[44:47], s69 offen offset:0 sc1
    v_pk_add_f32 v[8:9], v[8:9], v[90:91]
    v_pk_fma_f32 v[10:11], v[90:91], v[90:91], v[10:11]
    s_nop 0
    v_permlane32_swap_b32 v8, v9
    v_permlane32_swap_b32 v10, v11
    v_add_f32 v8, v8, v9
    v_add_f32 v10, v10, v11
    s_nop 1
    v_permlane16_swap_b32 v8, v10
    v_add_f32 v8, v8, v10
    s_nop 1
    v_add_f32_dpp v8, v8, v8 row_ror:8 row_mask:0xf bank_mask:0xf
    s_nop 1
    v_add_f32_dpp v8, v8, v8 row_ror:4 row_mask:0xf bank_mask:0xf
    s_nop 1
    v_add_f32_dpp v8, v8, v8 row_ror:2 row_mask:0xf bank_mask:0xf
    s_nop 1
    v_add_f32_dpp v8, v8, v8 row_ror:1 row_mask:0xf bank_mask:0xf
    v_mul_f32 v8, 0x3acccccd, v8
    s_nop 0
    v_readlane_b32 s56, v8, 0
    v_readlane_b32 s57, v8, 16
    v_readlane_b32 s58, v8, 32
    v_readlane_b32 s59, v8, 48
    v_mov_b32 v10, s56
    v_mov_b32 v11, s58
    v_fma_f32 v8, -v10, v10, s57
    v_fma_f32 v9, -v11, v11, s59
    v_max_f32 v8, 0, v8
    v_max_f32 v9, 0, v9
    v_add_f32 v8, 0x3727c5ac, v8
    v_add_f32 v9, 0x3727c5ac, v9
    v_rsq_f32 v8, v8
    v_rsq_f32 v9, v9
    s_lshl_b32 s56, s49, 8
    s_waitcnt lgkmcnt(0)
    buffer_store_dwordx4 a[12:15], v6, s[44:47], s69 offen offset:1024 sc1
    s_add_u32 s56, s56, 15360
    v_pk_mul_f32 v[10:11], v[10:11], v[8:9]
    v_pk_fma_f32 v[72:73], v[72:73], v[8:9], v[10:11] neg_lo:[0,0,1] neg_hi:[0,0,1]
    ds_write_b64 v92, v[72:73] offset:15360
    v_pk_fma_f32 v[74:75], v[74:75], v[8:9], v[10:11] neg_lo:[0,0,1] neg_hi:[0,0,1]
    ds_write_b64 v93, v[74:75] offset:15616
    v_pk_fma_f32 v[76:77], v[76:77], v[8:9], v[10:11] neg_lo:[0,0,1] neg_hi:[0,0,1]
    ds_write_b64 v94, v[76:77] offset:15872
    v_pk_fma_f32 v[78:79], v[78:79], v[8:9], v[10:11] neg_lo:[0,0,1] neg_hi:[0,0,1]
    ds_write_b64 v95, v[78:79] offset:16128
    v_pk_fma_f32 v[80:81], v[80:81], v[8:9], v[10:11] neg_lo:[0,0,1] neg_hi:[0,0,1]
    ds_write_b64 v96, v[80:81] offset:15368
    v_pk_fma_f32 v[82:83], v[82:83], v[8:9], v[10:11] neg_lo:[0,0,1] neg_hi:[0,0,1]
    ds_write_b64 v92, v[82:83] offset:15624
    v_pk_fma_f32 v[84:85], v[84:85], v[8:9], v[10:11] neg_lo:[0,0,1] neg_hi:[0,0,1]
    ds_write_b64 v93, v[84:85] offset:15880
    s_add_u32 m0, s85, 24576
    s_nop 0
    buffer_load_dwordx4 v196, s[8:11], 0 offen lds
    v_pk_fma_f32 v[86:87], v[86:87], v[8:9], v[10:11] neg_lo:[0,0,1] neg_hi:[0,0,1]
    ds_write_b64 v94, v[86:87] offset:16136
    v_pk_fma_f32 v[88:89], v[88:89], v[8:9], v[10:11] neg_lo:[0,0,1] neg_hi:[0,0,1]
    ds_write_b64 v97, v[88:89] offset:15360
    v_pk_fma_f32 v[90:91], v[90:91], v[8:9], v[10:11] neg_lo:[0,0,1] neg_hi:[0,0,1]
    ds_write_b64 v98, v[90:91] offset:15616
    v_lshl_add_u32 v9, v2, 3, s56
    v_lshl_add_u32 v8, v3, 10, v9
    s_waitcnt lgkmcnt(0)
    s_barrier
    ds_read2st64_b64 v[72:75], v8 offset0:0 offset1:60
    ds_read2st64_b64 v[76:79], v8 offset0:120 offset1:180
    ds_read2st64_b64 v[80:83], v8 offset0:4 offset1:64
    ds_read2st64_b64 v[84:87], v8 offset0:124 offset1:184
    ds_read2st64_b64 v[88:91], v9 offset0:8 offset1:68
    ds_read2st64_b64 v[92:95], v9 offset0:128 offset1:188
    buffer_load_dwordx4 v[24:27], v7, s[44:47], s76 offen sc1
    buffer_load_dwordx4 v[28:31], v7, s[44:47], s77 offen sc1
    buffer_load_dwordx4 v[32:35], v7, s[44:47], s78 offen sc1
    buffer_load_dwordx4 v[36:39], v7, s[44:47], s79 offen sc1
    buffer_load_dwordx4 v[40:43], v200, s[44:47], s76 offen sc1
    v_lshrrev_b32 v8, 3, v2
    v_cvt_f32_u32 v8, v8
    v_mul_f32 v8, 0x3ecccccd, v8
    v_and_b32 v9, 7, v1
    v_cvt_f32_u32 v9, v9
    v_mul_f32 v9, 0x3e000000, v9
    v_cvt_f32_u32 v10, v3
    v_mul_f32 v10, v10, v8
    v_and_b32 v18, 1, v1
    v_mul_u32_u24 v18, 0x8000, v18
    v_lshl_or_b32 v18, v18, 16, v18
    v_mov_b32 v11, v10
    v_mov_b32 v12, v11
    v_add_f32 v13, v9, v11
    v_cos_f32 v14, v12
    s_add_u32 m0, s85, 25600
    s_nop 0
    buffer_load_dwordx4 v197, s[8:11], 0 offen lds
    v_sin_f32 v16, v12
    v_cos_f32 v15, v13
    v_sin_f32 v17, v13
    v_cvt_pk_bf16_f32 v100, v14, v15
    v_cvt_pk_bf16_f32 v112, -v16, -v17
    v_fmamk_f32 v12, v9, 0x40000000, v11
    v_fmamk_f32 v13, v9, 0x40400000, v11
    v_cos_f32 v14, v12
    v_sin_f32 v16, v12
    v_cos_f32 v15, v13
    v_sin_f32 v17, v13
    v_cvt_pk_bf16_f32 v101, v14, v15
    v_cvt_pk_bf16_f32 v113, -v16, -v17
    v_fmamk_f32 v11, v8, 0x40000000, v10
    v_mov_b32 v12, v11
    v_add_f32 v13, v9, v11
    v_cos_f32 v14, v12
    v_sin_f32 v16, v12
    v_cos_f32 v15, v13
    v_sin_f32 v17, v13
    v_cvt_pk_bf16_f32 v104, v14, v15
    v_cvt_pk_bf16_f32 v116, -v16, -v17
    v_fmamk_f32 v12, v9, 0x40000000, v11
    v_fmamk_f32 v13, v9, 0x40400000, v11
    v_cos_f32 v14, v12
    v_sin_f32 v16, v12
    s_add_u32 m0, s85, 26624
    s_nop 0
    buffer_load_dwordx4 v198, s[8:11], 0 offen lds
    v_cos_f32 v15, v13
    v_sin_f32 v17, v13
    v_cvt_pk_bf16_f32 v105, v14, v15
    v_cvt_pk_bf16_f32 v117, -v16, -v17
    v_fmamk_f32 v11, v8, 0x40800000, v10
    v_mov_b32 v12, v11
    v_add_f32 v13, v9, v11
    v_cos_f32 v14, v12
    v_sin_f32 v16, v12
    v_cos_f32 v15, v13
    v_sin_f32 v17, v13
    v_cvt_pk_bf16_f32 v108, v14, v15
    v_cvt_pk_bf16_f32 v120, -v16, -v17
    v_fmamk_f32 v12, v9, 0x40000000, v11
    v_fmamk_f32 v13, v9, 0x40400000, v11
    v_cos_f32 v14, v12
    v_sin_f32 v16, v12
    v_cos_f32 v15, v13
    v_sin_f32 v17, v13
    v_cvt_pk_bf16_f32 v109, v14, v15
    v_cvt_pk_bf16_f32 v121, -v16, -v17
    s_mov_b32 exec_lo, 0
    v_mov_b32 v108, 0
    v_mov_b32 v120, 0
    v_mov_b32 v109, 0
    v_mov_b32 v121, 0
    s_mov_b32 exec_lo, -1
    s_add_u32 m0, s85, 27648
    s_nop 0
    buffer_load_dwordx4 v196, s[12:15], 0 offen lds
    v_xor_b32 v102, v18, v100
    v_xor_b32 v103, v18, v101
    v_xor_b32 v106, v18, v104
    v_xor_b32 v107, v18, v105
    v_xor_b32 v110, v18, v108
    v_xor_b32 v111, v18, v109
    v_xor_b32 v114, v18, v112
    v_xor_b32 v115, v18, v113
    v_xor_b32 v118, v18, v116
    v_xor_b32 v119, v18, v117
    v_xor_b32 v122, v18, v120
    v_xor_b32 v123, v18, v121
    v_permlane32_swap_b32 v60, v64
    v_permlane32_swap_b32 v61, v65
    v_permlane32_swap_b32 v62, v66
    v_permlane32_swap_b32 v63, v67
    v_permlane32_swap_b32 v68, v69
    v_accvgpr_write_b32 a240, v60
    v_accvgpr_write_b32 a241, v61
    v_accvgpr_write_b32 a242, v62
    v_accvgpr_write_b32 a243, v63
    v_accvgpr_write_b32 a244, v64
    v_accvgpr_write_b32 a245, v65
    v_accvgpr_write_b32 a246, v66
    v_accvgpr_write_b32 a247, v67
    v_accvgpr_write_b32 a248, v68
    v_accvgpr_write_b32 a249, v69
    v_cvt_f32_u32 v216, v2
    v_lshlrev_b32 v217, 4, v3
    v_add_u32 v217, s49, v217
    v_cvt_f32_u32 v217, v217
    v_mul_f32 v216, 0x3c000000, v216
    v_mul_f32 v217, v217, v216
    v_and_b32 v226, 1, v1
    v_mul_u32_u24 v226, 0x8000, v226
    v_lshl_or_b32 v226, v226, 16, v226
    v_mov_b32 v218, v217
    v_fmamk_f32 v221, v216, 0x40800000, v217
    v_cos_f32 v219, v218
    v_sin_f32 v220, v218
    v_cos_f32 v222, v221
    v_sin_f32 v223, v221
    v_cvt_pk_bf16_f32 v124, v219, v220
    v_cvt_pk_bf16_f32 v140, -v220, v219
L_chk_mod1:
    s_waitcnt vmcnt(7)
    v_xor_b32 v24, s72, v24
    v_xor_b32 v25, s73, v25
    v_xor_b32 v26, s74, v26
    v_xor_b32 v27, s75, v27
    v_or3_b32 v8, v24, v25, v26
    v_or_b32 v8, v8, v27
    s_waitcnt vmcnt(6)
    v_xor_b32 v28, s72, v28
    v_xor_b32 v29, s73, v29
    v_xor_b32 v30, s74, v30
    v_xor_b32 v31, s75, v31
    v_or3_b32 v8, v8, v28, v29
    v_or3_b32 v8, v8, v30, v31
    s_waitcnt vmcnt(5)
    v_xor_b32 v32, s72, v32
    v_xor_b32 v33, s73, v33
    v_xor_b32 v34, s74, v34
    v_xor_b32 v35, s75, v35
    v_or3_b32 v8, v8, v32, v33
    v_or3_b32 v8, v8, v34, v35
    s_waitcnt vmcnt(4)
    v_xor_b32 v36, s72, v36
    v_xor_b32 v37, s73, v37
    v_xor_b32 v38, s74, v38
    v_xor_b32 v39, s75, v39
    v_or3_b32 v8, v8, v36, v37
    v_or3_b32 v8, v8, v38, v39
    s_waitcnt vmcnt(3)
    v_xor_b32 v40, s72, v40
    v_xor_b32 v41, s73, v41
    v_xor_b32 v42, s74, v42
    v_xor_b32 v43, s75, v43
    v_or3_b32 v8, v8, v40, v41
    v_or3_b32 v8, v8, v42, v43
    v_and_b32 v8, 0xff, v8
    v_cmp_ne_u32 vcc, 0, v8
    s_cbranch_vccnz L_retry_mod1
L_ok_mod1:
    v_permlane32_swap_b32 v40, v41
    v_permlane32_swap_b32 v42, v43
    v_pk_add_f32 v[24:25], v[24:25], v[28:29]
    v_pk_add_f32 v[32:33], v[32:33], v[36:37]
    v_pk_add_f32 v[26:27], v[26:27], v[30:31]
    v_pk_add_f32 v[34:35], v[34:35], v[38:39]
    v_pk_add_f32 v[24:25], v[24:25], v[32:33]
    v_pk_add_f32 v[26:27], v[26:27], v[34:35]
    v_add_f32 v40, v40, v41
    v_add_f32 v42, v42, v43
    v_cvt_pk_bf16_f32 v8, v24, v25
    v_cvt_pk_bf16_f32 v9, v26, v27
    v_lshlrev_b32 v24, 16, v8
    v_and_b32 v25, s3, v8
    v_lshlrev_b32 v26, 16, v9
    v_and_b32 v27, s3, v9
    v_pk_add_f32 v[24:25], v[24:25], v[204:205] op_sel_hi:[1,0]
    v_pk_add_f32 v[26:27], v[26:27], v[204:205] op_sel_hi:[1,0]
    v_cvt_pk_bf16_f32 v8, v24, v25
    v_cvt_pk_bf16_f32 v9, v26, v27
    v_lshlrev_b32 v24, 16, v8
    v_and_b32 v25, s3, v8
    v_lshlrev_b32 v26, 16, v9
    v_and_b32 v27, s3, v9
    v_permlane16_swap_b32 v40, v42
    ds_write2st64_b32 v202, v24, v25 offset0:0 offset1:5
    ds_write2st64_b32 v202, v26, v27 offset0:10 offset1:15
    v_add_f32 v40, v40, v42
    v_cvt_pk_bf16_f32 v40, v40, v40
    v_lshlrev_b32 v40, 16, v40
    v_add_f32 v40, 1.0, v40
    v_cvt_pk_bf16_f32 v40, v40, v40
    v_lshlrev_b32 v40, 16, v40
    ds_write_b32 v201, v40
    v_cvt_pk_bf16_f32 v125, v222, v223
    v_cvt_pk_bf16_f32 v141, -v223, v222
    v_fmamk_f32 v218, v216, 0x41000000, v217
    v_fmamk_f32 v221, v216, 0x41400000, v217
    v_cos_f32 v219, v218
    v_sin_f32 v220, v218
    v_cos_f32 v222, v221
    s_waitcnt lgkmcnt(0)
    s_barrier
    s_add_u32 m0, s85, 28672
    s_nop 0
    buffer_load_dwordx4 v197, s[12:15], 0 offen lds
    ds_read2_b32 v[8:9], v205 offset0:0 offset1:160
    ds_read2_b32 v[10:11], v206 offset0:0 offset1:160
    ds_read2_b32 v[12:13], v207 offset0:0 offset1:160
    v_sin_f32 v223, v221
    v_cvt_pk_bf16_f32 v126, v219, v220
    v_cvt_pk_bf16_f32 v142, -v220, v219
    s_waitcnt lgkmcnt(2)
    v_pk_fma_f32 v[72:73], v[72:73], v[8:9], v[8:9] op_sel:[0,1,0] op_sel_hi:[1,1,0]
    v_pk_fma_f32 v[74:75], v[74:75], v[8:9], v[8:9] op_sel:[0,1,0] op_sel_hi:[1,1,0]
    v_pk_fma_f32 v[76:77], v[76:77], v[8:9], v[8:9] op_sel:[0,1,0] op_sel_hi:[1,1,0]
    v_pk_fma_f32 v[78:79], v[78:79], v[8:9], v[8:9] op_sel:[0,1,0] op_sel_hi:[1,1,0]
    s_waitcnt lgkmcnt(1)
    v_pk_fma_f32 v[80:81], v[80:81], v[10:11], v[10:11] op_sel:[0,1,0] op_sel_hi:[1,1,0]
    v_pk_fma_f32 v[82:83], v[82:83], v[10:11], v[10:11] op_sel:[0,1,0] op_sel_hi:[1,1,0]
    v_pk_fma_f32 v[84:85], v[84:85], v[10:11], v[10:11] op_sel:[0,1,0] op_sel_hi:[1,1,0]
    s_add_u32 m0, s85, 29696
    s_nop 0
    buffer_load_dwordx4 v198, s[12:15], 0 offen lds
    v_pk_fma_f32 v[86:87], v[86:87], v[10:11], v[10:11] op_sel:[0,1,0] op_sel_hi:[1,1,0]
    s_waitcnt lgkmcnt(0)
    v_pk_fma_f32 v[88:89], v[88:89], v[12:13], v[12:13] op_sel:[0,1,0] op_sel_hi:[1,1,0]
    v_pk_fma_f32 v[90:91], v[90:91], v[12:13], v[12:13] op_sel:[0,1,0] op_sel_hi:[1,1,0]
    v_pk_fma_f32 v[92:93], v[92:93], v[12:13], v[12:13] op_sel:[0,1,0] op_sel_hi:[1,1,0]
    v_pk_fma_f32 v[94:95], v[94:95], v[12:13], v[12:13] op_sel:[0,1,0] op_sel_hi:[1,1,0]
    v_cvt_pk_bf16_f32 v60, v72, v73
    v_cvt_pk_bf16_f32 v61, v74, v75
    v_cvt_pk_bf16_f32 v62, v76, v77
    v_cvt_pk_bf16_f32 v63, v78, v79
    v_cvt_pk_bf16_f32 v127, v222, v223
    v_cvt_pk_bf16_f32 v143, -v223, v222
    v_mfma_f32_32x32x16_bf16 v[24:39], v[60:63], v[100:103], 0
    s_add_u32 m0, s85, 0
    s_nop 0
    buffer_load_dwordx4 v240, s[16:19], s90 offen lds
    v_cvt_pk_bf16_f32 v64, v80, v81
    v_cvt_pk_bf16_f32 v65, v82, v83
    v_cvt_pk_bf16_f32 v66, v84, v85
    v_cvt_pk_bf16_f32 v67, v86, v87
    v_fmamk_f32 v218, v216, 0x42000000, v217
    v_fmamk_f32 v221, v216, 0x42100000, v217
    v_mfma_f32_32x32x16_bf16 v[40:55], v[60:63], v[112:115], 0
    s_add_u32 m0, s85, 1024
    s_nop 0
    buffer_load_dwordx4 v241, s[16:19], s90 offen lds
    v_cos_f32 v219, v218
    v_sin_f32 v220, v218
    v_cos_f32 v222, v221
    v_mfma_f32_32x32x16_bf16 v[24:39], v[64:67], v[104:107], v[24:39]
    v_cvt_pk_bf16_f32 v68, v88, v89
    v_cvt_pk_bf16_f32 v69, v90, v91
    v_cvt_pk_bf16_f32 v70, v92, v93
    s_add_u32 m0, s85, 2048
    s_add_u32 s90, s90, 49152
    buffer_load_dwordx4 v240, s[16:19], s90 offen lds
    v_cvt_pk_bf16_f32 v71, v94, v95
    v_sin_f32 v223, v221
    v_mfma_f32_32x32x16_bf16 v[40:55], v[64:67], v[116:119], v[40:55]
    v_cvt_pk_bf16_f32 v128, v219, v220
    v_cvt_pk_bf16_f32 v144, -v220, v219
    v_cvt_pk_bf16_f32 v129, v222, v223
    v_cvt_pk_bf16_f32 v145, -v223, v222
    v_fmamk_f32 v218, v216, 0x42200000, v217
    s_add_u32 m0, s85, 3072
    s_nop 0
    buffer_load_dwordx4 v241, s[16:19], s90 offen lds
    v_fmamk_f32 v221, v216, 0x42300000, v217
    v_mfma_f32_32x32x16_bf16 v[24:39], v[68:71], v[108:111], v[24:39]
    v_cos_f32 v219, v218
    v_sin_f32 v220, v218
    v_cos_f32 v222, v221
    v_mfma_f32_32x32x16_bf16 v[40:55], v[68:71], v[120:123], v[40:55]
    buffer_load_dwordx2 v[192:193], v245, s[28:31], 0 offen
    v_sin_f32 v223, v221
    v_cvt_pk_bf16_f32 v130, v219, v220
    v_cvt_pk_bf16_f32 v146, -v220, v219
    v_cvt_pk_bf16_f32 v131, v222, v223
    v_cvt_pk_bf16_f32 v147, -v223, v222
    v_xor_b32 v132, v226, v124
    v_xor_b32 v133, v226, v125
    v_mov_b32 v79, s50
    v_mov_b32 v83, s50
    v_mov_b32 v87, s50
    buffer_load_dwordx2 v[194:195], v244, s[20:23], 0 offen
    v_mov_b32 v91, s50
    v_cvt_pk_bf16_f32 v60, v24, v40
    v_cvt_pk_bf16_f32 v61, v25, v41
    v_cvt_pk_bf16_f32 v62, v26, v42
    v_cvt_pk_bf16_f32 v63, v27, v43
    v_xor_b32 v134, v226, v126
    v_xor_b32 v135, v226, v127
    v_mfma_f32_32x32x16_bf16 v[100:115], v[60:63], v[124:127], 0
    v_cvt_pk_bf16_f32 v64, v28, v44
    s_mov_b32 s93, 70656
    buffer_load_dwordx4 v[160:163], v7, s[44:47], s93 offen sc1
    v_cvt_pk_bf16_f32 v65, v29, v45
    v_cvt_pk_bf16_f32 v66, v30, v46
    v_cvt_pk_bf16_f32 v67, v31, v47
    v_xor_b32 v136, v226, v128
    v_xor_b32 v137, v226, v129
    v_mfma_f32_32x32x16_bf16 v[100:115], v[64:67], v[128:131], v[100:115]
    v_cvt_pk_bf16_f32 v68, v32, v48
    v_cvt_pk_bf16_f32 v69, v33, v49
    v_cvt_pk_bf16_f32 v70, v34, v50
    v_cvt_pk_bf16_f32 v71, v35, v51
    buffer_load_dwordx4 v[176:179], v246, s[44:47], s93 offen sc1
    v_xor_b32 v138, v226, v130
    v_xor_b32 v139, v226, v131
    v_mfma_f32_32x32x16_bf16 v[100:115], v[68:71], v[132:135], v[100:115]
    v_cvt_pk_bf16_f32 v72, v36, v52
    v_cvt_pk_bf16_f32 v73, v37, v53
    v_cvt_pk_bf16_f32 v74, v38, v54
    v_cvt_pk_bf16_f32 v75, v39, v55
    v_xor_b32 v148, v226, v140
    v_xor_b32 v149, v226, v141
    s_mov_b32 s93, 86016
    buffer_load_dwordx4 v[164:167], v7, s[44:47], s93 offen sc1
    v_mfma_f32_32x32x16_bf16 v[100:115], v[72:75], v[136:139], v[100:115]
    v_xor_b32 v150, v226, v142
    v_xor_b32 v151, v226, v143
    v_xor_b32 v152, v226, v144
    v_xor_b32 v153, v226, v145
    v_xor_b32 v154, v226, v146
    v_xor_b32 v155, v226, v147
    v_mfma_f32_32x32x16_bf16 v[24:39], v[60:63], v[140:143], 0
    buffer_load_dwordx4 v[180:183], v246, s[44:47], s93 offen sc1
    s_mul_i32 s56, s49, 6144
    s_add_u32 s56, s56, 122880
    v_lshl_add_u32 v208, v2, 3, s56
    v_lshl_add_u32 v208, v3, 10, v208
    v_add_u32 v209, 2048, v208
    v_add_u32 v210, 4096, v208
    v_mfma_f32_32x32x16_bf16 v[24:39], v[64:67], v[144:147], v[24:39]
    s_mov_b32 s93, 101376
    buffer_load_dwordx4 v[168:171], v7, s[44:47], s93 offen sc1
    ds_write2_b32 v208, v100, v101 offset0:0 offset1:64
    ds_write2_b32 v208, v102, v103 offset0:128 offset1:192
    v_lshrrev_b32 v228, 5, v0
    v_lshlrev_b32 v229, 8, v228
    v_add_u32 v230, 0, v2
    v_mfma_f32_32x32x16_bf16 v[24:39], v[68:71], v[148:151], v[24:39]
    buffer_load_dwordx4 v[184:187], v246, s[44:47], s93 offen sc1
    ds_write2_b32 v209, v104, v105 offset0:0 offset1:64
    ds_write2_b32 v209, v106, v107 offset0:128 offset1:192
    v_and_b32 v230, 31, v230
    v_lshl_add_u32 v230, v230, 3, v229
    v_add_u32 v211, 122880, v230
    v_mfma_f32_32x32x16_bf16 v[24:39], v[72:75], v[152:155], v[24:39]
    s_mov_b32 s93, 116736
    buffer_load_dwordx4 v[172:175], v7, s[44:47], s93 offen sc1
    ds_write2_b32 v210, v108, v109 offset0:0 offset1:64
    ds_write2_b32 v210, v110, v111 offset0:128 offset1:192
    v_add_u32 v230, 13, v2
    v_and_b32 v230, 31, v230
    v_lshl_add_u32 v230, v230, 3, v229
    v_add_u32 v212, 124928, v230
    v_add_u32 v230, 26, v2
    buffer_load_dwordx4 v[188:191], v246, s[44:47], s93 offen sc1
    v_and_b32 v230, 31, v230
    v_lshl_add_u32 v230, v230, 3, v229
    v_add_u32 v213, 126976, v230
    v_lshlrev_b32 v229, 4, v2
    v_sub_u32 v230, 8, v228
    ds_write2_b32 v208, v24, v25 offset0:1 offset1:65
    ds_write2_b32 v208, v26, v27 offset0:129 offset1:193
    ds_write2_b32 v209, v28, v29 offset0:1 offset1:65
    ds_write2_b32 v209, v30, v31 offset0:129 offset1:193
    ds_write2_b32 v210, v32, v33 offset0:1 offset1:65
    ds_write2_b32 v210, v34, v35 offset0:129 offset1:193
    v_and_b32 v230, 7, v230
    v_lshl_add_u32 v215, v230, 11, v229
    v_lshl_add_u32 v214, v228, 11, v229
    s_mul_i32 s80, s48, 16384
    s_add_u32 s80, s80, 1048576
    v_cmp_gt_u32 s[64:65], 19, v2
    s_waitcnt lgkmcnt(0)
    s_barrier
    ds_read_b64 v[32:33], v212 offset:0
    ds_read_b64 v[36:37], v212 offset:12288
    ds_read_b64 v[34:35], v212 offset:6144
    ds_read_b64 v[38:39], v212 offset:18432
    ds_read_b64 v[40:41], v213 offset:0
    ds_read_b64 v[44:45], v213 offset:12288
    ds_read_b64 v[42:43], v213 offset:6144
    ds_read_b64 v[46:47], v213 offset:18432
    ds_read_b64 v[24:25], v211 offset:0
    ds_read_b64 v[28:29], v211 offset:12288
    ds_read_b64 v[26:27], v211 offset:6144
    ds_read_b64 v[30:31], v211 offset:18432
    s_waitcnt lgkmcnt(10)
    v_pk_add_f32 v[48:49], v[32:33], v[36:37]
    v_pk_add_f32 v[50:51], v[32:33], v[36:37] neg_lo:[0,1] neg_hi:[0,1]
    s_waitcnt lgkmcnt(8)
    v_pk_add_f32 v[52:53], v[34:35], v[38:39]
    v_pk_add_f32 v[54:55], v[34:35], v[38:39] neg_lo:[0,1] neg_hi:[0,1]
    v_pk_add_f32 v[32:33], v[48:49], v[52:53]
    v_pk_add_f32 v[36:37], v[48:49], v[52:53] neg_lo:[0,1] neg_hi:[0,1]
    v_pk_add_f32 v[34:35], v[50:51], v[54:55] op_sel:[0,1] op_sel_hi:[1,0] neg_hi:[0,1]
    v_pk_add_f32 v[38:39], v[50:51], v[54:55] op_sel:[0,1] op_sel_hi:[1,0] neg_lo:[0,1]
    v_cvt_pk_bf16_f32 v56, v32, v33
    v_cvt_pk_bf16_f32 v57, v34, v35
    v_cvt_pk_bf16_f32 v58, v36, v37
    v_cvt_pk_bf16_f32 v59, v38, v39
    v_cndmask_b32_e64 v77, v59, v58, s[64:65]
    v_cndmask_b32_e64 v81, v56, v59, s[64:65]
    v_cndmask_b32_e64 v85, v57, v56, s[64:65]
    v_cndmask_b32_e64 v89, v58, v57, s[64:65]
    s_waitcnt lgkmcnt(6)
    v_pk_add_f32 v[48:49], v[40:41], v[44:45]
    v_pk_add_f32 v[50:51], v[40:41], v[44:45] neg_lo:[0,1] neg_hi:[0,1]
    s_waitcnt lgkmcnt(4)
    v_pk_add_f32 v[52:53], v[42:43], v[46:47]
    v_pk_add_f32 v[54:55], v[42:43], v[46:47] neg_lo:[0,1] neg_hi:[0,1]
    v_pk_add_f32 v[40:41], v[48:49], v[52:53]
    v_pk_add_f32 v[44:45], v[48:49], v[52:53] neg_lo:[0,1] neg_hi:[0,1]
    v_pk_add_f32 v[42:43], v[50:51], v[54:55] op_sel:[0,1] op_sel_hi:[1,0] neg_hi:[0,1]
    v_pk_add_f32 v[46:47], v[50:51], v[54:55] op_sel:[0,1] op_sel_hi:[1,0] neg_lo:[0,1]
    v_cvt_pk_bf16_f32 v56, v40, v41
    v_cvt_pk_bf16_f32 v57, v42, v43
    v_cvt_pk_bf16_f32 v58, v44, v45
    v_cvt_pk_bf16_f32 v59, v46, v47
    v_cmp_gt_u32 s[66:67], 6, v2
    s_nop 1
    v_cndmask_b32_e64 v78, v57, v56, s[66:67]
    v_cndmask_b32_e64 v82, v58, v57, s[66:67]
    v_cndmask_b32_e64 v86, v59, v58, s[66:67]
    v_cndmask_b32_e64 v90, v56, v59, s[66:67]
    s_waitcnt lgkmcnt(2)
    v_pk_add_f32 v[48:49], v[24:25], v[28:29]
    v_pk_add_f32 v[50:51], v[24:25], v[28:29] neg_lo:[0,1] neg_hi:[0,1]
    s_waitcnt lgkmcnt(0)
    v_pk_add_f32 v[52:53], v[26:27], v[30:31]
    v_pk_add_f32 v[54:55], v[26:27], v[30:31] neg_lo:[0,1] neg_hi:[0,1]
    v_pk_add_f32 v[24:25], v[48:49], v[52:53]
    v_pk_add_f32 v[28:29], v[48:49], v[52:53] neg_lo:[0,1] neg_hi:[0,1]
    v_pk_add_f32 v[26:27], v[50:51], v[54:55] op_sel:[0,1] op_sel_hi:[1,0] neg_hi:[0,1]
    v_pk_add_f32 v[30:31], v[50:51], v[54:55] op_sel:[0,1] op_sel_hi:[1,0] neg_lo:[0,1]
    v_cvt_pk_bf16_f32 v76, v24, v25
    buffer_store_dwordx4 v[76:79], v214, s[44:47], s80 offen offset:0 sc1
    v_cvt_pk_bf16_f32 v80, v26, v27
    buffer_store_dwordx4 v[80:83], v214, s[44:47], s80 offen offset:512 sc1
    v_cvt_pk_bf16_f32 v84, v28, v29
    buffer_store_dwordx4 v[84:87], v215, s[44:47], s80 offen offset:1024 sc1
    v_cvt_pk_bf16_f32 v88, v30, v31
    buffer_store_dwordx4 v[88:91], v215, s[44:47], s80 offen offset:1536 sc1
    s_getpc_b64 s[58:59]
L_pc1:
    v_and_b32 v8, 7, v1
    v_lshl_add_u32 v8, v8, 5, s52
    v_lshlrev_b32 v8, 7, v8
    v_min_u32 v8, L_last-L_pc1, v8
    v_mov_b32 v9, s59
    v_add_co_u32 v8, vcc, s58, v8
    s_nop 1
    v_addc_co_u32 v9, vcc, 0, v9, vcc
    global_load_dword v248, v[8:9], off
    s_add_u32 m0, s85, 4096
    s_add_u32 s90, s90, 49152
    buffer_load_dwordx4 v240, s[16:19], s90 offen lds
    v_cvt_f32_u32 v8, v4
    v_cvt_f32_u32 v9, v5
    v_cvt_f32_u32 v10, s53
    v_mul_f32 v9, 4.0, v9
    v_fmamk_f32 v11, v8, 0x41000000, v10
    v_mul_f32 v11, 0x3c000000, v11
    v_mul_f32 v12, 0x3d800000, v8
    v_mul_f32 v13, 0x3c000000, v8
    v_mul_f32 v13, v13, v10
    v_add_f32 v14, 0x00000000, v9
    v_mul_f32 v15, v14, v11
    v_mul_f32 v16, 0x3d800000, v15
    v_mul_f32 v17, v14, v12
    s_add_u32 m0, s85, 5120
    s_nop 0
    buffer_load_dwordx4 v241, s[16:19], s90 offen lds
    v_add_f32 v18, v17, v13
    v_mul_f32 v19, 0x3d800000, v18
    v_cos_f32 v20, v15
    v_sin_f32 v21, v15
    v_cos_f32 v108, v16
    v_sin_f32 v112, v16
    v_cvt_pk_bf16_f32 v100, v20, v21
    v_cvt_pk_bf16_f32 v104, -v21, v20
    v_cos_f32 v20, v17
    s_add_u32 m0, s85, 6144
    s_add_u32 s90, s90, 49152
    buffer_load_dwordx4 v240, s[16:19], s90 offen lds
    v_sin_f32 v21, v17
    v_cos_f32 v22, v18
    v_sin_f32 v23, v18
    v_cos_f32 v132, v19
    v_sin_f32 v136, v19
    v_cvt_pk_bf16_f32 v116, v20, v21
    v_cvt_pk_bf16_f32 v120, -v21, v20
    s_add_u32 m0, s85, 7168
    s_nop 0
    buffer_load_dwordx4 v241, s[16:19], s90 offen lds
    v_cvt_pk_bf16_f32 v124, v20, -v21
    v_cvt_pk_bf16_f32 v128, v21, v20
    v_cvt_pk_bf16_f32 v140, v22, -v23
    v_cvt_pk_bf16_f32 v144, v23, v22
    v_add_f32 v14, 0x3f800000, v9
    v_mul_f32 v15, v14, v11
    v_mul_f32 v16, 0x3d800000, v15
    v_mul_f32 v17, v14, v12
    v_add_f32 v18, v17, v13
    v_mul_f32 v19, 0x3d800000, v18
    v_cos_f32 v20, v15
    v_sin_f32 v21, v15
    v_cos_f32 v109, v16
    v_sin_f32 v113, v16
    v_cvt_pk_bf16_f32 v101, v20, v21
    v_cvt_pk_bf16_f32 v105, -v21, v20
    v_cos_f32 v20, v17
    v_sin_f32 v21, v17
    v_cos_f32 v22, v18
    v_sin_f32 v23, v18
    v_cos_f32 v133, v19
    v_sin_f32 v137, v19
    v_cvt_pk_bf16_f32 v117, v20, v21
    v_cvt_pk_bf16_f32 v121, -v21, v20
    v_cvt_pk_bf16_f32 v125, v20, -v21
    v_cvt_pk_bf16_f32 v129, v21, v20
    v_cvt_pk_bf16_f32 v141, v22, -v23
    v_cvt_pk_bf16_f32 v145, v23, v22
    v_add_f32 v14, 0x40000000, v9
    v_mul_f32 v15, v14, v11
    v_mul_f32 v16, 0x3d800000, v15
    v_mul_f32 v17, v14, v12
    v_add_f32 v18, v17, v13
    v_mul_f32 v19, 0x3d800000, v18
    v_cos_f32 v20, v15
    v_sin_f32 v21, v15
    v_cos_f32 v110, v16
    v_sin_f32 v114, v16
    v_cvt_pk_bf16_f32 v102, v20, v21
    v_cvt_pk_bf16_f32 v106, -v21, v20
    v_cos_f32 v20, v17
    v_sin_f32 v21, v17
    v_cos_f32 v22, v18
    v_sin_f32 v23, v18
    v_cos_f32 v134, v19
    v_sin_f32 v138, v19
    v_cvt_pk_bf16_f32 v118, v20, v21
    v_cvt_pk_bf16_f32 v122, -v21, v20
    v_cvt_pk_bf16_f32 v126, v20, -v21
    v_cvt_pk_bf16_f32 v130, v21, v20
    v_cvt_pk_bf16_f32 v142, v22, -v23
    v_cvt_pk_bf16_f32 v146, v23, v22
    v_add_f32 v14, 0x40400000, v9
    v_mul_f32 v15, v14, v11
    v_mul_f32 v16, 0x3d800000, v15
    v_mul_f32 v17, v14, v12
    v_add_f32 v18, v17, v13
    v_mul_f32 v19, 0x3d800000, v18
    v_cos_f32 v20, v15
    v_sin_f32 v21, v15
    v_cos_f32 v111, v16
    v_sin_f32 v115, v16
    v_cvt_pk_bf16_f32 v103, v20, v21
    v_cvt_pk_bf16_f32 v107, -v21, v20
    v_cos_f32 v20, v17
    v_sin_f32 v21, v17
    v_cos_f32 v22, v18
    v_sin_f32 v23, v18
    v_cos_f32 v135, v19
    v_sin_f32 v139, v19
    v_cvt_pk_bf16_f32 v119, v20, v21
    v_cvt_pk_bf16_f32 v123, -v21, v20
    v_cvt_pk_bf16_f32 v127, v20, -v21
    v_cvt_pk_bf16_f32 v131, v21, v20
    v_cvt_pk_bf16_f32 v143, v22, -v23
    v_cvt_pk_bf16_f32 v147, v23, v22
    v_lshrrev_b32 v8, 2, v1
    v_mul_u32_u24 v8, 16384, v8
    v_and_b32 v9, 3, v1
    v_lshl_add_u32 v148, v9, 4, v8
    s_mul_i32 s56, s49, 1048576
    s_lshl_b32 s68, s48, 6
    s_add_u32 s56, s56, s68
    s_add_u32 s76, s56, 1048576
    s_add_u32 s77, s76, 262144
    s_add_u32 s78, s76, 524288
    s_add_u32 s79, s76, 786432
    v_mul_u32_u24 v8, 3104, v9
    v_lshrrev_b32 v9, 2, v0
    v_lshl_add_u32 v8, v9, 4, v8
    s_mul_i32 s56, s49, 3104
    v_add_u32 v9, s56, v6
    v_add_u32 v151, 122880, v8
    v_add_u32 v152, 122880, v9
    v_add_u32 v149, 147456, v8
    v_add_u32 v150, 147456, v9
    s_mul_i32 s80, s48, 16384
    s_lshl_b32 s57, s49, 12
    s_add_u32 s80, s80, s57
    s_add_u32 s80, s80, 5242880
    v_mov_b32 v154, s50
    s_waitcnt vmcnt(23)
    s_barrier
    s_lshr_b32 s56, s70, 1
    s_lshl_b32 s56, s56, 2
    s_add_u32 s56, s56, 24576
    s_and_b32 s70, s70, 1
    s_lshl_b32 s70, s70, 4
    v_mul_u32_u24 v12, 30720, v5
    v_mul_u32_u24 v13, 48, v4
    v_add3_u32 v196, v12, v13, s56
    v_add_u32 v197, 1536, v196
    v_add_u32 v198, 3072, v196
    v_add_u32 v199, 4608, v196
    ds_read2_b32 v[200:201], v196 offset0:0 offset1:1
    ds_read2_b32 v[202:203], v198 offset0:0 offset1:1
    ds_read2_b32 v[204:205], v196 offset0:192 offset1:193
    ds_read2_b32 v[206:207], v198 offset0:192 offset1:193
    ds_read2_b32 v[208:209], v197 offset0:0 offset1:1
    ds_read2_b32 v[210:211], v199 offset0:0 offset1:1
    ds_read2_b32 v[212:213], v197 offset0:192 offset1:193
    ds_read2_b32 v[214:215], v199 offset0:192 offset1:193
    s_cmp_lt_u32 s52, 16
    s_cselect_b64 vcc, -1, 0
    s_cselect_b32 s59, 0, 0x80000000
    s_mov_b32 s56, 0x354ccccd
    s_mov_b32 s57, 0x35cccccd
    s_xor_b32 s58, s56, s59
    s_xor_b32 s59, s57, s59
    s_waitcnt lgkmcnt(7)
    v_lshrrev_b64 v[200:201], s70, v[200:201]
    v_lshlrev_b32 v12, 16, v200
    v_lshlrev_b32 v13, 16, v201
    v_and_b32 v14, s3, v200
    v_cndmask_b32_e64 v15, v13, v12, vcc
    v_cndmask_b32_e64 v16, v12, v13, vcc
    v_mul_f32 v224, s57, v14
    v_mul_f32 v216, s56, v15
    v_mul_f32 v232, s57, v16
    s_waitcnt lgkmcnt(6)
    v_lshrrev_b64 v[202:203], s70, v[202:203]
    v_lshlrev_b32 v12, 16, v202
    v_lshlrev_b32 v13, 16, v203
    v_and_b32 v14, s3, v202
    v_cndmask_b32_e64 v15, v13, v12, vcc
    v_cndmask_b32_e64 v16, v12, v13, vcc
    v_mul_f32 v228, s59, v14
    v_mul_f32 v220, s58, v15
    v_mul_f32 v236, s59, v16
    s_waitcnt lgkmcnt(5)
    v_lshrrev_b64 v[204:205], s70, v[204:205]
    v_lshlrev_b32 v12, 16, v204
    v_lshlrev_b32 v13, 16, v205
    v_and_b32 v14, s3, v204
    v_cndmask_b32_e64 v15, v13, v12, vcc
    v_cndmask_b32_e64 v16, v12, v13, vcc
    v_mul_f32 v225, s57, v14
    v_mul_f32 v217, s56, v15
    v_mul_f32 v233, s57, v16
    s_waitcnt lgkmcnt(4)
    v_lshrrev_b64 v[206:207], s70, v[206:207]
    v_lshlrev_b32 v12, 16, v206
    v_lshlrev_b32 v13, 16, v207
    v_and_b32 v14, s3, v206
    v_cndmask_b32_e64 v15, v13, v12, vcc
    v_cndmask_b32_e64 v16, v12, v13, vcc
    v_mul_f32 v229, s59, v14
    v_mul_f32 v221, s58, v15
    v_mul_f32 v237, s59, v16
    s_waitcnt lgkmcnt(3)
    v_lshrrev_b64 v[208:209], s70, v[208:209]
    v_lshlrev_b32 v12, 16, v208
    v_lshlrev_b32 v13, 16, v209
    v_and_b32 v14, s3, v208
    v_cndmask_b32_e64 v15, v13, v12, vcc
    v_cndmask_b32_e64 v16, v12, v13, vcc
    v_mul_f32 v226, s57, v14
    v_mul_f32 v218, s56, v15
    v_mul_f32 v234, s57, v16
    s_waitcnt lgkmcnt(2)
    v_lshrrev_b64 v[210:211], s70, v[210:211]
    v_lshlrev_b32 v12, 16, v210
    v_lshlrev_b32 v13, 16, v211
    v_and_b32 v14, s3, v210
    v_cndmask_b32_e64 v15, v13, v12, vcc
    v_cndmask_b32_e64 v16, v12, v13, vcc
    v_mul_f32 v230, s59, v14
    v_mul_f32 v222, s58, v15
    v_mul_f32 v238, s59, v16
    s_waitcnt lgkmcnt(1)
    v_lshrrev_b64 v[212:213], s70, v[212:213]
    v_lshlrev_b32 v12, 16, v212
    v_lshlrev_b32 v13, 16, v213
    v_and_b32 v14, s3, v212
    v_cndmask_b32_e64 v15, v13, v12, vcc
    v_cndmask_b32_e64 v16, v12, v13, vcc
    v_mul_f32 v227, s57, v14
    v_mul_f32 v219, s56, v15
    v_mul_f32 v235, s57, v16
    s_waitcnt lgkmcnt(0)
    v_lshrrev_b64 v[214:215], s70, v[214:215]
    v_lshlrev_b32 v12, 16, v214
    v_lshlrev_b32 v13, 16, v215
    v_and_b32 v14, s3, v214
    v_cndmask_b32_e64 v15, v13, v12, vcc
    v_cndmask_b32_e64 v16, v12, v13, vcc
    v_mul_f32 v231, s59, v14
    v_mul_f32 v223, s58, v15
    v_mul_f32 v239, s59, v16
L_chk_mod2:
    s_waitcnt vmcnt(16)
    v_xor_b32 v160, s72, v160
    v_xor_b32 v161, s73, v161
    v_xor_b32 v162, s74, v162
    v_xor_b32 v163, s75, v163
    v_or3_b32 v8, v160, v161, v162
    v_or_b32 v8, v8, v163
    s_waitcnt vmcnt(14)
    v_xor_b32 v164, s72, v164
    v_xor_b32 v165, s73, v165
    v_xor_b32 v166, s74, v166
    v_xor_b32 v167, s75, v167
    v_or3_b32 v8, v8, v164, v165
    v_or3_b32 v8, v8, v166, v167
    s_waitcnt vmcnt(12)
    v_xor_b32 v168, s72, v168
    v_xor_b32 v169, s73, v169
    v_xor_b32 v170, s74, v170
    v_xor_b32 v171, s75, v171
    v_or3_b32 v8, v8, v168, v169
    v_or3_b32 v8, v8, v170, v171
    s_waitcnt vmcnt(10)
    v_xor_b32 v172, s72, v172
    v_xor_b32 v173, s73, v173
    v_xor_b32 v174, s74, v174
    v_xor_b32 v175, s75, v175
    v_or3_b32 v8, v8, v172, v173
    v_or3_b32 v8, v8, v174, v175
    v_xor_b32 v176, s72, v176
    v_xor_b32 v177, s73, v177
    v_xor_b32 v178, s74, v178
    v_xor_b32 v179, s75, v179
    v_or3_b32 v8, v8, v176, v177
    v_or3_b32 v8, v8, v178, v179
    v_xor_b32 v180, s72, v180
    v_xor_b32 v181, s73, v181
    v_xor_b32 v182, s74, v182
    v_xor_b32 v183, s75, v183
    v_or3_b32 v8, v8, v180, v181
    v_or3_b32 v8, v8, v182, v183
    v_xor_b32 v184, s72, v184
    v_xor_b32 v185, s73, v185
    v_xor_b32 v186, s74, v186
    v_xor_b32 v187, s75, v187
    v_or3_b32 v8, v8, v184, v185
    v_or3_b32 v8, v8, v186, v187
    s_waitcnt vmcnt(9)
    v_xor_b32 v188, s72, v188
    v_xor_b32 v189, s73, v189
    v_xor_b32 v190, s74, v190
    v_xor_b32 v191, s75, v191
    v_or3_b32 v8, v8, v188, v189
    v_or3_b32 v8, v8, v190, v191
    v_and_b32 v8, 0xff, v8
    v_cmp_ne_u32 vcc, 0, v8
    s_cbranch_vccnz L_retry_mod2
L_ok_mod2:
    v_subrev_u32 v10, 64, v0
    v_cmp_gt_u32 vcc, 160, v10
    s_nop 1
    v_cndmask_b32_e64 v10, 0, 1.0, vcc
    v_add_u32 v13, 135296, v7
    v_pk_add_f32 v[160:161], v[160:161], v[164:165]
    v_pk_add_f32 v[168:169], v[168:169], v[172:173]
    v_pk_add_f32 v[162:163], v[162:163], v[166:167]
    v_pk_add_f32 v[170:171], v[170:171], v[174:175]
    v_pk_add_f32 v[160:161], v[160:161], v[168:169]
    v_pk_add_f32 v[162:163], v[162:163], v[170:171]
    v_cvt_pk_bf16_f32 v8, v160, v161
    v_cvt_pk_bf16_f32 v9, v162, v163
    v_lshlrev_b32 v160, 16, v8
    v_and_b32 v161, s3, v8
    v_lshlrev_b32 v162, 16, v9
    v_and_b32 v163, s3, v9
    ds_write_b128 v13, v[160:163] offset:0
    v_pk_add_f32 v[176:177], v[176:177], v[180:181]
    v_pk_add_f32 v[184:185], v[184:185], v[188:189]
    v_pk_add_f32 v[178:179], v[178:179], v[182:183]
    v_pk_add_f32 v[186:187], v[186:187], v[190:191]
    v_pk_add_f32 v[176:177], v[176:177], v[184:185]
    v_pk_add_f32 v[178:179], v[178:179], v[186:187]
    buffer_load_dwordx4 v[24:27], v148, s[44:47], s76 offen sc1
    buffer_load_dwordx4 v[28:31], v148, s[44:47], s77 offen sc1
    buffer_load_dwordx4 v[32:35], v148, s[44:47], s78 offen sc1
    buffer_load_dwordx4 v[36:39], v148, s[44:47], s79 offen sc1
    v_cvt_pk_bf16_f32 v8, v176, v177
    v_cvt_pk_bf16_f32 v9, v178, v179
    v_lshlrev_b32 v176, 16, v8
    v_and_b32 v177, s3, v8
    v_lshlrev_b32 v178, 16, v9
    v_and_b32 v179, s3, v9
    v_pk_add_f32 v[176:177], v[176:177], v[10:11] op_sel_hi:[1,0]
    v_pk_add_f32 v[178:179], v[178:179], v[10:11] op_sel_hi:[1,0]
    v_cvt_pk_bf16_f32 v8, v176, v177
    v_cvt_pk_bf16_f32 v9, v178, v179
    v_lshlrev_b32 v176, 16, v8
    v_and_b32 v177, s3, v8
    v_lshlrev_b32 v178, 16, v9
    v_and_b32 v179, s3, v9
    v_lshlrev_b32 v14, 16, v192
    v_and_b32 v15, s3, v192
    v_lshlrev_b32 v16, 16, v193
    v_and_b32 v17, s3, v193
    v_mov_b32 v11, 0x40088e99
    v_cmp_lt_u32 vcc, 223, v0
    s_nop 1
    v_cndmask_b32_e64 v10, 1.0, v11, vcc
    v_pk_mul_f32 v[14:15], v[14:15], v[176:177]
    v_pk_mul_f32 v[176:177], v[176:177], v[10:11] op_sel_hi:[1,0]
    v_pk_mul_f32 v[16:17], v[16:17], v[178:179]
    v_pk_mul_f32 v[178:179], v[178:179], v[10:11] op_sel_hi:[1,0]
    v_max_u32 v11, 3568, v7
    v_add_u32 v11, 139920, v11
    ds_write_b128 v11, v[14:17]
    ds_write_b128 v13, v[176:179] offset:4096
    s_nop 0
    v_lshlrev_b32 v14, 16, v194
    v_and_b32 v15, s3, v194
    v_lshlrev_b32 v16, 16, v195
    v_and_b32 v17, s3, v195
    s_mov_b32 s58, 0x3eeff558
    s_mov_b32 s56, 144512
    v_pk_mul_f32 v[14:15], v[14:15], s[58:59] op_sel_hi:[1,0]
    v_pk_mul_f32 v[16:17], v[16:17], s[58:59] op_sel_hi:[1,0]
    v_lshl_add_u32 v11, v2, 4, s56
    ds_write_b128 v11, v[14:17]
    v_accvgpr_read_b32 v88, a240
    v_accvgpr_read_b32 v89, a241
    v_accvgpr_read_b32 v90, a242
    v_accvgpr_read_b32 v91, a243
    v_accvgpr_read_b32 v92, a244
    v_accvgpr_read_b32 v93, a245
    v_accvgpr_read_b32 v94, a246
    v_accvgpr_read_b32 v95, a247
    v_accvgpr_read_b32 v96, a248
    v_accvgpr_read_b32 v97, a249
    v_lshlrev_b32 v156, 16, v88
    v_and_b32 v157, s3, v88
    v_lshlrev_b32 v158, 16, v89
    v_and_b32 v159, s3, v89
    v_lshlrev_b32 v160, 16, v90
    v_and_b32 v161, s3, v90
    v_lshlrev_b32 v162, 16, v91
    v_and_b32 v163, s3, v91
    v_lshlrev_b32 v164, 16, v92
    v_and_b32 v165, s3, v92
    v_lshlrev_b32 v166, 16, v93
    v_and_b32 v167, s3, v93
    v_lshlrev_b32 v168, 16, v94
    v_and_b32 v169, s3, v94
    v_lshlrev_b32 v170, 16, v95
    v_and_b32 v171, s3, v95
    v_lshlrev_b32 v172, 16, v96
    v_and_b32 v173, s3, v96
    v_lshlrev_b32 v174, 16, v97
    v_and_b32 v175, s3, v97
    s_mul_i32 s84, s49, 491520
    s_and_b32 s56, s55, 7
    s_mul_i32 s56, s56, 5120
    s_add_u32 s84, s84, s56
    s_add_u32 s69, s84, 21233664
    s_mul_i32 s86, s55, 40960
    s_mul_i32 s56, s49, 10240
    s_add_u32 s86, s86, s56
    s_add_u32 s86, s86, 18874368
L_chk_t:
    s_waitcnt vmcnt(1)
    v_min3_u32 v8, v27, v31, v35
    v_max3_u32 v9, v27, v31, v35
    s_waitcnt vmcnt(0)
    v_min3_u32 v8, v8, v39, s50
    v_max3_u32 v9, v9, v39, s50
    v_cmp_ne_u32 vcc, v8, v9
    s_cbranch_vccnz L_retry_t
L_ok_t:
    v_pk_mov_b32 v[40:41], v[24:25], v[28:29] op_sel:[0,0]
    v_pk_mov_b32 v[42:43], v[32:33], v[36:37] op_sel:[0,0]
    ds_write_b128 v149, v[40:43] offset:0
    v_pk_mov_b32 v[44:45], v[24:25], v[28:29] op_sel:[1,1]
    v_pk_mov_b32 v[46:47], v[32:33], v[36:37] op_sel:[1,1]
    ds_write_b128 v149, v[44:47] offset:1024
    v_pk_mov_b32 v[48:49], v[26:27], v[30:31] op_sel:[0,0]
    v_pk_mov_b32 v[50:51], v[34:35], v[38:39] op_sel:[0,0]
    ds_write_b128 v149, v[48:51] offset:2048
    s_waitcnt lgkmcnt(0)
    s_barrier
    s_add_u32 m0, s85, 8192
    s_add_u32 s90, s90, 49152
    buffer_load_dwordx4 v240, s[16:19], s90 offen lds
    ds_read_b128 v[24:27], v150 offset:0
    ds_read_b128 v[28:31], v150 offset:1024
    ds_read_b128 v[32:35], v150 offset:2048
    s_waitcnt lgkmcnt(2)
    v_mfma_f32_16x16x32_bf16 v[40:43], v[24:27], v[100:103], 0
    v_mfma_f32_16x16x32_bf16 v[44:47], v[24:27], v[104:107], 0
    s_add_u32 m0, s85, 9216
    s_nop 0
    buffer_load_dwordx4 v241, s[16:19], s90 offen lds
    s_waitcnt lgkmcnt(1)
    v_mfma_f32_16x16x32_bf16 v[48:51], v[28:31], v[100:103], 0
    v_mfma_f32_16x16x32_bf16 v[52:55], v[28:31], v[104:107], 0
    s_add_u32 m0, s85, 10240
    s_add_u32 s90, s90, 49152
    buffer_load_dwordx4 v240, s[16:19], s90 offen lds
    s_waitcnt lgkmcnt(0)
    v_mfma_f32_16x16x32_bf16 v[56:59], v[32:35], v[100:103], 0
    v_mfma_f32_16x16x32_bf16 v[60:63], v[32:35], v[104:107], 0
    v_pk_mul_f32 v[64:65], v[40:41], v[108:109]
    v_pk_mul_f32 v[68:69], v[44:45], v[108:109]
    v_pk_mul_f32 v[66:67], v[42:43], v[110:111]
    v_pk_mul_f32 v[70:71], v[46:47], v[110:111]
    s_add_u32 m0, s85, 11264
    s_nop 0
    buffer_load_dwordx4 v241, s[16:19], s90 offen lds
    v_pk_fma_f32 v[64:65], v[44:45], v[112:113], v[64:65]
    v_pk_fma_f32 v[68:69], v[40:41], v[112:113], v[68:69] neg_lo:[1,0,0] neg_hi:[1,0,0]
    v_pk_fma_f32 v[66:67], v[46:47], v[114:115], v[66:67]
    v_pk_fma_f32 v[70:71], v[42:43], v[114:115], v[70:71] neg_lo:[1,0,0] neg_hi:[1,0,0]
    v_pk_mul_f32 v[72:73], v[48:49], v[108:109]
    v_pk_mul_f32 v[76:77], v[52:53], v[108:109]
    v_pk_mul_f32 v[74:75], v[50:51], v[110:111]
    v_pk_mul_f32 v[78:79], v[54:55], v[110:111]
    v_pk_fma_f32 v[72:73], v[52:53], v[112:113], v[72:73]
    v_pk_fma_f32 v[76:77], v[48:49], v[112:113], v[76:77] neg_lo:[1,0,0] neg_hi:[1,0,0]
    v_pk_fma_f32 v[74:75], v[54:55], v[114:115], v[74:75]
    v_pk_fma_f32 v[78:79], v[50:51], v[114:115], v[78:79] neg_lo:[1,0,0] neg_hi:[1,0,0]
    v_pk_mul_f32 v[80:81], v[56:57], v[108:109]
    v_pk_mul_f32 v[84:85], v[60:61], v[108:109]
    v_pk_mul_f32 v[82:83], v[58:59], v[110:111]
    v_pk_mul_f32 v[86:87], v[62:63], v[110:111]
    v_pk_fma_f32 v[80:81], v[60:61], v[112:113], v[80:81]
    s_add_u32 m0, s85, 12288
    s_add_u32 s90, s90, 49152
    buffer_load_dwordx4 v240, s[16:19], s90 offen lds
    v_pk_fma_f32 v[84:85], v[56:57], v[112:113], v[84:85] neg_lo:[1,0,0] neg_hi:[1,0,0]
    v_pk_fma_f32 v[82:83], v[62:63], v[114:115], v[82:83]
    v_pk_fma_f32 v[86:87], v[58:59], v[114:115], v[86:87] neg_lo:[1,0,0] neg_hi:[1,0,0]
    v_cvt_pk_bf16_f32 v24, v64, v68
    v_cvt_pk_bf16_f32 v25, v65, v69
    v_cvt_pk_bf16_f32 v26, v66, v70
    v_cvt_pk_bf16_f32 v27, v67, v71
    v_cvt_pk_bf16_f32 v28, v72, v76
    v_cvt_pk_bf16_f32 v29, v73, v77
    v_mfma_f32_16x16x32_bf16 v[40:43], v[116:119], v[24:27], 0
    v_cvt_pk_bf16_f32 v30, v74, v78
    s_add_u32 m0, s85, 13312
    s_nop 0
    buffer_load_dwordx4 v241, s[16:19], s90 offen lds
    v_cvt_pk_bf16_f32 v31, v75, v79
    v_mfma_f32_16x16x32_bf16 v[44:47], v[120:123], v[24:27], 0
    v_cvt_pk_bf16_f32 v32, v80, v84
    v_cvt_pk_bf16_f32 v33, v81, v85
    v_mfma_f32_16x16x32_bf16 v[48:51], v[116:119], v[28:31], 0
    v_cvt_pk_bf16_f32 v34, v82, v86
    v_cvt_pk_bf16_f32 v35, v83, v87
    s_add_u32 m0, s85, 14336
    s_add_u32 s90, s90, 49152
    buffer_load_dwordx4 v240, s[16:19], s90 offen lds
    v_mfma_f32_16x16x32_bf16 v[52:55], v[120:123], v[28:31], 0
    v_mfma_f32_16x16x32_bf16 v[56:59], v[116:119], v[32:35], 0
    v_mfma_f32_16x16x32_bf16 v[60:63], v[120:123], v[32:35], 0
    s_add_u32 m0, s85, 15360
    s_nop 0
    buffer_load_dwordx4 v241, s[16:19], s90 offen lds
    v_pk_mul_f32 v[64:65], v[40:41], v[216:217]
    v_pk_mul_f32 v[68:69], v[44:45], v[216:217]
    v_pk_mul_f32 v[66:67], v[42:43], v[218:219]
    v_pk_mul_f32 v[70:71], v[46:47], v[218:219]
    v_pk_fma_f32 v[64:65], v[44:45], v[220:221], v[64:65] neg_lo:[1,0,0] neg_hi:[1,0,0]
    v_pk_fma_f32 v[68:69], v[40:41], v[220:221], v[68:69]
    v_pk_fma_f32 v[66:67], v[46:47], v[222:223], v[66:67] neg_lo:[1,0,0] neg_hi:[1,0,0]
    v_pk_fma_f32 v[70:71], v[42:43], v[222:223], v[70:71]
    v_pk_mul_f32 v[72:73], v[48:49], v[224:225]
    v_pk_mul_f32 v[76:77], v[52:53], v[224:225]
    v_pk_mul_f32 v[74:75], v[50:51], v[226:227]
    v_pk_mul_f32 v[78:79], v[54:55], v[226:227]
    v_pk_fma_f32 v[72:73], v[52:53], v[228:229], v[72:73] neg_lo:[1,0,0] neg_hi:[1,0,0]
    v_pk_fma_f32 v[76:77], v[48:49], v[228:229], v[76:77]
    v_pk_fma_f32 v[74:75], v[54:55], v[230:231], v[74:75] neg_lo:[1,0,0] neg_hi:[1,0,0]
    v_pk_fma_f32 v[78:79], v[50:51], v[230:231], v[78:79]
    s_add_u32 s84, s69, 0
    buffer_load_dwordx4 a[0:3], v6, s[44:47], s84 offen offset:0 sc1
    v_pk_mul_f32 v[80:81], v[56:57], v[232:233]
    v_pk_mul_f32 v[84:85], v[60:61], v[232:233]
    v_pk_mul_f32 v[82:83], v[58:59], v[234:235]
    v_pk_mul_f32 v[86:87], v[62:63], v[234:235]
    v_pk_fma_f32 v[80:81], v[60:61], v[236:237], v[80:81] neg_lo:[1,0,0] neg_hi:[1,0,0]
    v_pk_fma_f32 v[84:85], v[56:57], v[236:237], v[84:85]
    v_pk_fma_f32 v[82:83], v[62:63], v[238:239], v[82:83] neg_lo:[1,0,0] neg_hi:[1,0,0]
    v_pk_fma_f32 v[86:87], v[58:59], v[238:239], v[86:87]
    v_cvt_pk_bf16_f32 v24, v64, v68
    v_cvt_pk_bf16_f32 v25, v65, v69
    v_cvt_pk_bf16_f32 v26, v66, v70
    v_cvt_pk_bf16_f32 v27, v67, v71
    v_cvt_pk_bf16_f32 v28, v72, v76
    v_cvt_pk_bf16_f32 v29, v73, v77
    v_mfma_f32_16x16x32_bf16 v[40:43], v[24:27], v[124:127], 0
    buffer_load_dwordx4 a[4:7], v6, s[44:47], s84 offen offset:1024 sc1
    v_cvt_pk_bf16_f32 v30, v74, v78
    v_cvt_pk_bf16_f32 v31, v75, v79
    v_mfma_f32_16x16x32_bf16 v[44:47], v[24:27], v[128:131], 0
    v_cvt_pk_bf16_f32 v32, v80, v84
    v_cvt_pk_bf16_f32 v33, v81, v85
    v_mfma_f32_16x16x32_bf16 v[48:51], v[28:31], v[124:127], 0
    buffer_load_dwordx4 a[8:11], v6, s[44:47], s84 offen offset:2048 sc1
    v_cvt_pk_bf16_f32 v34, v82, v86
    v_cvt_pk_bf16_f32 v35, v83, v87
    v_mfma_f32_16x16x32_bf16 v[52:55], v[28:31], v[128:131], 0
    s_nop 0
    v_mfma_f32_16x16x32_bf16 v[56:59], v[32:35], v[124:127], 0
    buffer_load_dwordx4 a[12:15], v6, s[44:47], s84 offen offset:3072 sc1
    v_mfma_f32_16x16x32_bf16 v[60:63], v[32:35], v[128:131], 0
    v_pk_mul_f32 v[64:65], v[40:41], v[132:133]
    v_pk_mul_f32 v[68:69], v[44:45], v[132:133]
    v_pk_mul_f32 v[66:67], v[42:43], v[134:135]
    v_pk_mul_f32 v[70:71], v[46:47], v[134:135]
    v_pk_fma_f32 v[64:65], v[44:45], v[136:137], v[64:65] neg_lo:[1,0,0] neg_hi:[1,0,0]
    v_pk_fma_f32 v[68:69], v[40:41], v[136:137], v[68:69]
    v_pk_fma_f32 v[66:67], v[46:47], v[138:139], v[66:67] neg_lo:[1,0,0] neg_hi:[1,0,0]
    v_pk_fma_f32 v[70:71], v[42:43], v[138:139], v[70:71]
    v_pk_mul_f32 v[72:73], v[48:49], v[132:133]
    v_pk_mul_f32 v[76:77], v[52:53], v[132:133]
    s_add_u32 s84, s69, 4096
    buffer_load_dwordx4 a[16:19], v6, s[44:47], s84 offen offset:0 sc1
    v_pk_mul_f32 v[74:75], v[50:51], v[134:135]
    v_pk_mul_f32 v[78:79], v[54:55], v[134:135]
    v_pk_fma_f32 v[72:73], v[52:53], v[136:137], v[72:73] neg_lo:[1,0,0] neg_hi:[1,0,0]
    v_pk_fma_f32 v[76:77], v[48:49], v[136:137], v[76:77]
    v_pk_fma_f32 v[74:75], v[54:55], v[138:139], v[74:75] neg_lo:[1,0,0] neg_hi:[1,0,0]
    v_pk_fma_f32 v[78:79], v[50:51], v[138:139], v[78:79]
    v_pk_mul_f32 v[80:81], v[56:57], v[132:133]
    v_pk_mul_f32 v[84:85], v[60:61], v[132:133]
    v_pk_mul_f32 v[82:83], v[58:59], v[134:135]
    v_pk_mul_f32 v[86:87], v[62:63], v[134:135]
    v_pk_fma_f32 v[80:81], v[60:61], v[136:137], v[80:81] neg_lo:[1,0,0] neg_hi:[1,0,0]
    v_pk_fma_f32 v[84:85], v[56:57], v[136:137], v[84:85]
    v_pk_fma_f32 v[82:83], v[62:63], v[138:139], v[82:83] neg_lo:[1,0,0] neg_hi:[1,0,0]
    v_pk_fma_f32 v[86:87], v[58:59], v[138:139], v[86:87]
    v_cvt_pk_bf16_f32 v24, v64, v68
    v_cvt_pk_bf16_f32 v25, v65, v69
    v_cvt_pk_bf16_f32 v26, v66, v70
    s_add_u32 s84, s69, 40960
    buffer_load_dwordx4 a[20:23], v6, s[44:47], s84 offen offset:0 sc1
    v_cvt_pk_bf16_f32 v27, v67, v71
    v_cvt_pk_bf16_f32 v28, v72, v76
    v_cvt_pk_bf16_f32 v29, v73, v77
    v_mfma_f32_16x16x32_bf16 v[40:43], v[140:143], v[24:27], 0
    v_cvt_pk_bf16_f32 v30, v74, v78
    v_cvt_pk_bf16_f32 v31, v75, v79
    v_mfma_f32_16x16x32_bf16 v[44:47], v[144:147], v[24:27], 0
    s_lshl_b32 s92, s54, 6
    s_add_u32 s92, s92, 1024
    v_lshlrev_b32 v243, 2, v4
    buffer_load_dword v243, v243, s[44:47], s92 offen sc1
    v_cvt_pk_bf16_f32 v32, v80, v84
    v_cvt_pk_bf16_f32 v33, v81, v85
    v_mfma_f32_16x16x32_bf16 v[48:51], v[140:143], v[28:31], 0
    v_cvt_pk_bf16_f32 v34, v82, v86
    v_cvt_pk_bf16_f32 v35, v83, v87
    v_mfma_f32_16x16x32_bf16 v[52:55], v[144:147], v[28:31], 0
    s_lshl_b32 s92, s54, 10
    s_add_u32 s92, s92, 32768
    buffer_load_dword v250, v6, s[44:47], s92 offen sc1
    v_mfma_f32_16x16x32_bf16 v[56:59], v[140:143], v[32:35], 0
    v_mfma_f32_16x16x32_bf16 v[60:63], v[144:147], v[32:35], 0
    v_cvt_pk_bf16_f32 v24, v40, v44
    v_cvt_pk_bf16_f32 v25, v41, v45
    v_cvt_pk_bf16_f32 v26, v42, v46
    v_cvt_pk_bf16_f32 v27, v43, v47
    ds_write_b128 v152, v[24:27] offset:0
    s_cmp_eq_u32 s48, 0
    s_cselect_b32 s92, 0, 2146435072
    v_mov_b32 v247, s50
    buffer_store_dword v247, off, s[44:47], s92 sc1
    v_cvt_pk_bf16_f32 v28, v48, v52
    v_cvt_pk_bf16_f32 v29, v49, v53
    v_cvt_pk_bf16_f32 v30, v50, v54
    v_cvt_pk_bf16_f32 v31, v51, v55
    ds_write_b128 v152, v[28:31] offset:1024
    v_cvt_pk_bf16_f32 v32, v56, v60
    v_cvt_pk_bf16_f32 v33, v57, v61
    v_cvt_pk_bf16_f32 v34, v58, v62
    v_cvt_pk_bf16_f32 v35, v59, v63
    ds_write_b128 v152, v[32:35] offset:2048
    s_waitcnt lgkmcnt(0)
    s_barrier
    ds_read_b128 v[40:43], v151 offset:0
    ds_read_b128 v[44:47], v151 offset:1024
    ds_read_b128 v[48:51], v151 offset:2048
    s_waitcnt lgkmcnt(1)
    v_pk_mov_b32 v[64:65], v[40:41], v[44:45] op_sel:[0,0]
    s_waitcnt lgkmcnt(0)
    v_pk_mov_b32 v[66:67], v[48:49], v[154:155] op_sel:[0,0]
    buffer_store_dwordx4 v[64:67], v6, s[44:47], s80 offen offset:0 sc1
    v_pk_mov_b32 v[68:69], v[40:41], v[44:45] op_sel:[1,1]
    v_pk_mov_b32 v[70:71], v[48:49], v[154:155] op_sel:[1,0]
    buffer_store_dwordx4 v[68:71], v6, s[44:47], s80 offen offset:1024 sc1
    v_pk_mov_b32 v[72:73], v[42:43], v[46:47] op_sel:[0,0]
    v_pk_mov_b32 v[74:75], v[50:51], v[154:155] op_sel:[0,0]
    buffer_store_dwordx4 v[72:75], v6, s[44:47], s80 offen offset:2048 sc1
    v_pk_mov_b32 v[76:77], v[42:43], v[46:47] op_sel:[1,1]
    v_pk_mov_b32 v[78:79], v[50:51], v[154:155] op_sel:[1,0]
    buffer_store_dwordx4 v[76:79], v6, s[44:47], s80 offen offset:3072 sc1
    s_getpc_b64 s[58:59]
L_pc2:
    v_and_b32 v8, 7, v1
    v_lshl_add_u32 v8, v8, 5, s52
    v_lshlrev_b32 v8, 7, v8
    v_min_u32 v8, L_last-L_pc2, v8
    v_mov_b32 v9, s59
    v_add_co_u32 v8, vcc, s58, v8
    s_nop 1
    v_addc_co_u32 v9, vcc, 0, v9, vcc
    global_load_dword v249, v[8:9], off
    buffer_load_dwordx4 a[24:27], v6, s[44:47], s84 offen offset:1024 sc1
    v_lshrrev_b32 v8, 5, v0
    v_sub_u32 v9, 8, v8
    v_and_b32 v9, 7, v9
    v_lshrrev_b32 v10, 2, v2
    v_lshl_add_u32 v8, v8, 5, v10
    v_lshl_add_u32 v9, v9, 5, v10
    v_mul_u32_u24 v8, 16384, v8
    v_mul_u32_u24 v9, 16384, v9
    v_and_b32 v10, 3, v1
    v_lshl_add_u32 v236, v10, 4, v8
    v_lshl_add_u32 v237, v10, 4, v9
    s_add_u32 s76, s68, 5242880
    s_add_u32 s77, s76, 131072
    s_add_u32 s78, s76, 262144
    s_add_u32 s79, s76, 393216
    v_lshlrev_b32 v8, 2, v2
    v_add_u32 v8, s49, v8
    v_cvt_f32_u32 v8, v8
    v_mul_f32 v8, 0x3c000000, v8
    buffer_load_dwordx4 a[28:31], v6, s[44:47], s84 offen offset:2048 sc1
    v_cvt_f32_u32 v16, v3
    v_mul_f32 v16, 4.0, v16
    v_mul_f32 v9, v16, v8
    v_mov_b32 v10, v9
    v_add_f32 v13, v8, v9
    v_cos_f32 v11, v10
    v_sin_f32 v12, v10
    v_cos_f32 v14, v13
    v_sin_f32 v15, v13
    v_cvt_pk_bf16_f32 v100, v11, -v12
    v_cvt_pk_bf16_f32 v116, v12, v11
    v_cvt_pk_bf16_f32 v101, v14, -v15
    v_cvt_pk_bf16_f32 v117, v15, v14
    v_fmamk_f32 v10, v8, 0x40000000, v9
    v_fmamk_f32 v13, v8, 0x40400000, v9
    buffer_load_dwordx4 a[32:35], v6, s[44:47], s84 offen offset:3072 sc1
    v_cos_f32 v11, v10
    v_sin_f32 v12, v10
    v_cos_f32 v14, v13
    v_sin_f32 v15, v13
    v_cvt_pk_bf16_f32 v102, v11, -v12
    v_cvt_pk_bf16_f32 v118, v12, v11
    v_cvt_pk_bf16_f32 v103, v14, -v15
    v_cvt_pk_bf16_f32 v119, v15, v14
    v_fmamk_f32 v10, v8, 0x41000000, v9
    v_fmamk_f32 v13, v8, 0x41100000, v9
    v_cos_f32 v11, v10
    v_sin_f32 v12, v10
    v_cos_f32 v14, v13
    s_add_u32 s84, s69, 45056
    buffer_load_dwordx4 a[36:39], v6, s[44:47], s84 offen offset:0 sc1
    v_sin_f32 v15, v13
    v_cvt_pk_bf16_f32 v104, v11, -v12
    v_cvt_pk_bf16_f32 v120, v12, v11
    v_cvt_pk_bf16_f32 v105, v14, -v15
    v_cvt_pk_bf16_f32 v121, v15, v14
    v_fmamk_f32 v10, v8, 0x41200000, v9
    v_fmamk_f32 v13, v8, 0x41300000, v9
    v_cos_f32 v11, v10
    v_sin_f32 v12, v10
    v_cos_f32 v14, v13
    v_sin_f32 v15, v13
    v_cvt_pk_bf16_f32 v106, v11, -v12
    v_cvt_pk_bf16_f32 v122, v12, v11
    s_add_u32 s84, s69, 122880
    buffer_load_dwordx4 a[60:63], v6, s[44:47], s84 offen offset:0 sc1
    v_cvt_pk_bf16_f32 v107, v14, -v15
    v_cvt_pk_bf16_f32 v123, v15, v14
    v_fmamk_f32 v10, v8, 0x41800000, v9
    v_fmamk_f32 v13, v8, 0x41880000, v9
    v_cos_f32 v11, v10
    v_sin_f32 v12, v10
    v_cos_f32 v14, v13
    v_sin_f32 v15, v13
    v_cvt_pk_bf16_f32 v108, v11, -v12
    v_cvt_pk_bf16_f32 v124, v12, v11
    v_cvt_pk_bf16_f32 v109, v14, -v15
    v_cvt_pk_bf16_f32 v125, v15, v14
    v_fmamk_f32 v10, v8, 0x41900000, v9
    v_fmamk_f32 v13, v8, 0x41980000, v9
    v_cos_f32 v11, v10
    v_sin_f32 v12, v10
    v_cos_f32 v14, v13
    v_sin_f32 v15, v13
    v_cvt_pk_bf16_f32 v110, v11, -v12
    v_cvt_pk_bf16_f32 v126, v12, v11
    v_cvt_pk_bf16_f32 v111, v14, -v15
    v_cvt_pk_bf16_f32 v127, v15, v14
    v_fmamk_f32 v10, v8, 0x41c00000, v9
    v_fmamk_f32 v13, v8, 0x41c80000, v9
    v_cos_f32 v11, v10
    v_sin_f32 v12, v10
    v_cos_f32 v14, v13
    v_sin_f32 v15, v13
    v_cvt_pk_bf16_f32 v112, v11, -v12
    v_cvt_pk_bf16_f32 v128, v12, v11
    v_cvt_pk_bf16_f32 v113, v14, -v15
    v_cvt_pk_bf16_f32 v129, v15, v14
    v_fmamk_f32 v10, v8, 0x41d00000, v9
    v_fmamk_f32 v13, v8, 0x41d80000, v9
    v_cos_f32 v11, v10
    v_sin_f32 v12, v10
    v_cos_f32 v14, v13
    v_sin_f32 v15, v13
    v_cvt_pk_bf16_f32 v114, v11, -v12
    v_cvt_pk_bf16_f32 v130, v12, v11
    v_cvt_pk_bf16_f32 v115, v14, -v15
    v_cvt_pk_bf16_f32 v131, v15, v14
    v_lshrrev_b32 v8, 3, v2
    v_cvt_f32_u32 v8, v8
    v_mul_f32 v8, 0x3ecccccd, v8
    v_and_b32 v9, 7, v1
    v_cvt_f32_u32 v9, v9
    v_mul_f32 v9, 0x3e000000, v9
    v_mul_f32 v17, v16, v9
    v_mov_b32 v18, v17
    v_mov_b32 v10, v18
    v_cos_f32 v11, v10
    v_sin_f32 v12, v10
    s_nop 0
    v_cvt_pk_bf16_f32 v132, v11, -v12
    v_mov_b32 v144, v132
    v_add_f32 v10, v8, v18
    v_cos_f32 v11, v10
    v_sin_f32 v12, v10
    v_add_f32 v13, 0x3fcccccd, v18
    v_cos_f32 v14, v13
    v_sin_f32 v15, v13
    v_cvt_pk_bf16_f32 v136, v11, -v12
    v_cvt_pk_bf16_f32 v148, v14, -v15
    v_fmamk_f32 v10, v8, 0x40000000, v18
    v_cos_f32 v11, v10
    v_sin_f32 v12, v10
    v_add_f32 v13, 0x404ccccd, v18
    v_cos_f32 v14, v13
    v_sin_f32 v15, v13
    v_cvt_pk_bf16_f32 v140, v11, -v12
    v_cvt_pk_bf16_f32 v152, v14, -v15
    v_add_f32 v18, v9, v17
    v_mov_b32 v10, v18
    v_cos_f32 v11, v10
    v_sin_f32 v12, v10
    s_nop 0
    v_cvt_pk_bf16_f32 v133, v11, -v12
    v_mov_b32 v145, v133
    v_add_f32 v10, v8, v18
    v_cos_f32 v11, v10
    v_sin_f32 v12, v10
    v_add_f32 v13, 0x3fcccccd, v18
    v_cos_f32 v14, v13
    v_sin_f32 v15, v13
    v_cvt_pk_bf16_f32 v137, v11, -v12
    v_cvt_pk_bf16_f32 v149, v14, -v15
    v_fmamk_f32 v10, v8, 0x40000000, v18
    v_cos_f32 v11, v10
    v_sin_f32 v12, v10
    v_add_f32 v13, 0x404ccccd, v18
    v_cos_f32 v14, v13
    v_sin_f32 v15, v13
    v_cvt_pk_bf16_f32 v141, v11, -v12
    v_cvt_pk_bf16_f32 v153, v14, -v15
    v_fmamk_f32 v18, v9, 0x40000000, v17
    v_mov_b32 v10, v18
    v_cos_f32 v11, v10
    v_sin_f32 v12, v10
    s_nop 0
    v_cvt_pk_bf16_f32 v134, v11, -v12
    v_mov_b32 v146, v134
    v_add_f32 v10, v8, v18
    v_cos_f32 v11, v10
    v_sin_f32 v12, v10
    v_add_f32 v13, 0x3fcccccd, v18
    v_cos_f32 v14, v13
    v_sin_f32 v15, v13
    v_cvt_pk_bf16_f32 v138, v11, -v12
    v_cvt_pk_bf16_f32 v150, v14, -v15
    v_fmamk_f32 v10, v8, 0x40000000, v18
    v_cos_f32 v11, v10
    v_sin_f32 v12, v10
    v_add_f32 v13, 0x404ccccd, v18
    v_cos_f32 v14, v13
    v_sin_f32 v15, v13
    v_cvt_pk_bf16_f32 v142, v11, -v12
    v_cvt_pk_bf16_f32 v154, v14, -v15
    v_fmamk_f32 v18, v9, 0x40400000, v17
    v_mov_b32 v10, v18
    v_cos_f32 v11, v10
    v_sin_f32 v12, v10
    s_nop 0
    v_cvt_pk_bf16_f32 v135, v11, -v12
    v_mov_b32 v147, v135
    v_add_f32 v10, v8, v18
    v_cos_f32 v11, v10
    v_sin_f32 v12, v10
    v_add_f32 v13, 0x3fcccccd, v18
    v_cos_f32 v14, v13
    v_sin_f32 v15, v13
    v_cvt_pk_bf16_f32 v139, v11, -v12
    v_cvt_pk_bf16_f32 v151, v14, -v15
    v_fmamk_f32 v10, v8, 0x40000000, v18
    v_cos_f32 v11, v10
    v_sin_f32 v12, v10
    v_add_f32 v13, 0x404ccccd, v18
    v_cos_f32 v14, v13
    v_sin_f32 v15, v13
    v_cvt_pk_bf16_f32 v143, v11, -v12
    v_cvt_pk_bf16_f32 v155, v14, -v15
    v_lshrrev_b32 v95, 5, v0
    v_mul_u32_u24 v95, 144, v95
    v_add_u32 v96, 0, v2
    v_and_b32 v96, 31, v96
    v_lshl_add_u32 v96, v96, 2, v95
    v_add_u32 v8, 147456, v96
    v_add_u32 v96, 13, v2
    v_and_b32 v96, 31, v96
    v_lshl_add_u32 v96, v96, 2, v95
    v_add_u32 v9, 148608, v96
    v_add_u32 v96, 26, v2
    v_and_b32 v96, 31, v96
    v_lshl_add_u32 v96, v96, 2, v95
    v_add_u32 v10, 149760, v96
    s_mul_i32 s56, s49, 3584
    s_add_u32 s56, s56, 147456
    v_mul_u32_u24 v95, 144, v2
    v_lshl_add_u32 v95, v3, 4, v95
    v_add_u32 v11, s56, v95
    v_lshl_add_u32 v95, v2, 2, s49
    v_mul_u32_u24 v96, 3, v95
    v_mul_u32_u24 v97, 5120, v3
    v_lshl_add_u32 v95, v95, 2, v97
    v_add_u32 v95, 122880, v95
    v_and_b32 v99, 16, v1
    v_xor_b32 v95, v95, v99
    v_add_u32 v97, 0, v96
    v_mul_u32_u24 v98, 205, v97
    v_lshrrev_b32 v98, 10, v98
    v_mad_i32_i24 v97, v98, -5, v97
    v_lshl_add_u32 v12, v97, 9, v95
    v_add_u32 v97, 2, v96
    v_mul_u32_u24 v98, 205, v97
    v_lshrrev_b32 v98, 10, v98
    v_mad_i32_i24 v97, v98, -5, v97
    v_lshl_add_u32 v13, v97, 9, v95
    v_add_u32 v97, 4, v96
    v_mul_u32_u24 v98, 205, v97
    v_lshrrev_b32 v98, 10, v98
    v_mad_i32_i24 v97, v98, -5, v97
    v_lshl_add_u32 v14, v97, 9, v95
    v_add_u32 v97, 6, v96
    v_mul_u32_u24 v98, 205, v97
    v_lshrrev_b32 v98, 10, v98
    v_mad_i32_i24 v97, v98, -5, v97
    v_lshl_add_u32 v15, v97, 9, v95
    v_add_u32 v97, 8, v96
    v_mul_u32_u24 v98, 205, v97
    v_lshrrev_b32 v98, 10, v98
    v_mad_i32_i24 v97, v98, -5, v97
    v_lshl_add_u32 v16, v97, 9, v95
    s_mul_i32 s56, s49, 2560
    s_add_u32 s57, s56, 122880
    v_lshl_add_u32 v84, v2, 5, s57
    v_lshl_add_u32 v85, v2, 4, s57
    v_xor_b32 v85, v85, v99
    v_and_b32 v99, 8, v1
    v_lshl_add_u32 v84, v99, 1, v84
    v_xor_b32 v92, 16, v84
    s_mov_b32 s57, 135296
    v_lshl_add_u32 v93, v2, 5, s57
    v_lshl_add_u32 v94, v2, 4, s57
    v_mov_b32 v95, 0x01000c0c
    v_mov_b32 v96, 0x03020c0c
    v_cmp_eq_u32 vcc, 1, v3
    s_nop 1
    v_cndmask_b32_e64 v86, v95, v96, vcc
    s_lshl_b32 s83, s49, 9
    s_add_u32 s83, s83, s48
    s_mul_i32 s83, s83, 1280
    s_mul_i32 s80, s55, 10
    s_add_u32 s80, s80, s49
    s_mul_i32 s80, s80, 16384
    s_lshl_b32 s57, s54, 10
    s_add_u32 s80, s80, s57
    s_add_u32 s80, s80, 1048576
    s_add_u32 s81, s80, 65536
    s_add_u32 s82, s80, 131072
    s_cmp_lt_u32 s49, 2
    s_cselect_b32 s82, s82, 2146435072
    v_mul_u32_u24 v95, 327680, v3
    v_lshl_add_u32 v87, v2, 4, v95
    v_lshl_add_u32 v88, v2, 3, v95
    s_lshl_b32 s58, s49, 1
    v_add_u32 v95, s58, v3
    v_xor_b32 v96, v95, v2
    v_and_b32 v96, 7, v96
    v_lshlrev_b32 v96, 4, v96
    v_lshl_add_u32 v96, v2, 7, v96
    v_add_u32 v89, 147456, v96
    buffer_load_dwordx4 v[24:27], v236, s[44:47], s76 offen sc1
    buffer_load_dwordx4 v[28:31], v236, s[44:47], s77 offen sc1
    buffer_load_dwordx4 v[32:35], v237, s[44:47], s78 offen sc1
    buffer_load_dwordx4 v[36:39], v237, s[44:47], s79 offen sc1
    v_lshrrev_b32 v97, 1, v2
    v_xor_b32 v98, v95, v97
    v_and_b32 v98, 7, v98
    v_lshlrev_b32 v98, 4, v98
    v_lshl_add_u32 v98, v97, 7, v98
    v_and_b32 v97, 1, v1
    v_lshl_add_u32 v98, v97, 3, v98
    v_add_u32 v90, 155648, v98
    v_lshrrev_b32 v97, 3, v0
    v_xor_b32 v99, v97, v0
    v_and_b32 v99, 7, v99
    v_lshlrev_b32 v99, 4, v99
    v_lshl_add_u32 v99, v97, 7, v99
    v_add_u32 v91, 147456, v99
    v_mov_b32 v22, 0x383ef424
    s_waitcnt vmcnt(16)
    v_cmp_ne_u32 vcc, s94, v243
    s_nop 0
    s_cmp_eq_u64 vcc, 0
    s_cselect_b32 s95, 1, 0
    s_lshl_b32 s92, s54, 10
    s_add_u32 s92, s92, 32768
    s_lshl_b32 s93, s55, 2
    s_add_u32 s93, s93, s49
    s_lshl_b32 s93, s93, 2
    v_mov_b32 v252, s93
    s_add_u32 m0, s85, 16384
    s_add_u32 s90, s90, 49152
    buffer_load_dwordx4 v240, s[16:19], s90 offen lds
    v_mov_b32 v253, s50
    s_lshl_b32 s93, s49, 6
    s_waitcnt vmcnt(16)
    v_lshl_add_u32 v250, v4, 2, s93
    ds_read_b128 v[176:179], v93 offset:0
    ds_read_b128 v[180:183], v93 offset:16
    ds_read_b128 v[184:187], v93 offset:1024
    ds_read_b128 v[188:191], v93 offset:1040
    s_add_u32 m0, s85, 17408
    s_nop 0
    buffer_load_dwordx4 v241, s[16:19], s90 offen lds
    ds_read_b128 v[192:195], v94 offset:2048
    ds_read_b128 v[196:199], v93 offset:2560
    ds_read_b128 v[200:203], v93 offset:2576
    ds_read_b128 v[204:207], v93 offset:3584
    s_add_u32 m0, s85, 18432
    s_add_u32 s90, s90, 49152
    buffer_load_dwordx4 v240, s[16:19], s90 offen lds
    ds_read_b128 v[208:211], v93 offset:3600
    ds_read_b128 v[212:215], v94 offset:4608
    ds_read_b128 v[216:219], v93 offset:5120
    ds_read_b128 v[220:223], v93 offset:5136
    s_add_u32 m0, s85, 19456
    s_nop 0
    buffer_load_dwordx4 v241, s[16:19], s90 offen lds
    ds_read_b128 v[224:227], v93 offset:6144
    ds_read_b128 v[228:231], v93 offset:6160
    ds_read_b128 v[232:235], v94 offset:7168
L_chk_tp:
    s_waitcnt vmcnt(5)
    v_min3_u32 v18, v27, v31, v35
    v_max3_u32 v19, v27, v31, v35
    s_waitcnt vmcnt(4)
    v_min3_u32 v18, v18, v39, s50
    v_max3_u32 v19, v19, v39, s50
    v_cmp_ne_u32 vcc, v18, v19
    s_cbranch_vccnz L_retry_tp
L_ok_tp:
    buffer_load_dwordx4 a[64:67], v6, s[44:47], s84 offen offset:1024 sc1
    v_lshlrev_b32 v40, 16, v24
    v_and_b32 v41, s3, v24
    v_lshlrev_b32 v42, 16, v28
    v_and_b32 v43, s3, v28
    v_lshlrev_b32 v44, 16, v32
    v_and_b32 v45, s3, v32
    v_lshlrev_b32 v46, 16, v36
    v_and_b32 v47, s3, v36
    v_pk_add_f32 v[48:49], v[40:41], v[44:45]
    v_pk_add_f32 v[50:51], v[40:41], v[44:45] neg_lo:[0,1] neg_hi:[0,1]
    v_pk_add_f32 v[52:53], v[42:43], v[46:47]
    v_pk_add_f32 v[54:55], v[42:43], v[46:47] neg_lo:[0,1] neg_hi:[0,1]
    v_pk_add_f32 v[40:41], v[48:49], v[52:53]
    v_pk_add_f32 v[44:45], v[48:49], v[52:53] neg_lo:[0,1] neg_hi:[0,1]
    v_pk_add_f32 v[42:43], v[50:51], v[54:55] op_sel:[0,1] op_sel_hi:[1,0] neg_lo:[0,1]
    v_pk_add_f32 v[46:47], v[50:51], v[54:55] op_sel:[0,1] op_sel_hi:[1,0] neg_hi:[0,1]
    v_cvt_pk_bf16_f32 v40, v40, v41
    v_cvt_pk_bf16_f32 v44, v44, v45
    ds_write2st64_b32 v8, v40, v44 offset0:0 offset1:28
    buffer_load_dwordx4 a[68:71], v6, s[44:47], s84 offen offset:2048 sc1
    v_cvt_pk_bf16_f32 v42, v42, v43
    v_cvt_pk_bf16_f32 v46, v46, v47
    ds_write2st64_b32 v8, v42, v46 offset0:14 offset1:42
    v_cndmask_b32_e64 v56, v29, v33, s[64:65]
    v_cndmask_b32_e64 v57, v33, v37, s[64:65]
    v_cndmask_b32_e64 v58, v37, v25, s[64:65]
    v_cndmask_b32_e64 v59, v25, v29, s[64:65]
    v_lshlrev_b32 v60, 16, v56
    v_and_b32 v61, s3, v56
    v_lshlrev_b32 v62, 16, v57
    v_and_b32 v63, s3, v57
    v_lshlrev_b32 v64, 16, v58
    v_and_b32 v65, s3, v58
    v_lshlrev_b32 v66, 16, v59
    v_and_b32 v67, s3, v59
    v_pk_add_f32 v[48:49], v[60:61], v[64:65]
    v_pk_add_f32 v[50:51], v[60:61], v[64:65] neg_lo:[0,1] neg_hi:[0,1]
    buffer_load_dwordx4 a[72:75], v6, s[44:47], s84 offen offset:3072 sc1
    v_pk_add_f32 v[52:53], v[62:63], v[66:67]
    v_pk_add_f32 v[54:55], v[62:63], v[66:67] neg_lo:[0,1] neg_hi:[0,1]
    v_pk_add_f32 v[60:61], v[48:49], v[52:53]
    v_pk_add_f32 v[64:65], v[48:49], v[52:53] neg_lo:[0,1] neg_hi:[0,1]
    v_pk_add_f32 v[62:63], v[50:51], v[54:55] op_sel:[0,1] op_sel_hi:[1,0] neg_lo:[0,1]
    v_pk_add_f32 v[66:67], v[50:51], v[54:55] op_sel:[0,1] op_sel_hi:[1,0] neg_hi:[0,1]
    v_cvt_pk_bf16_f32 v60, v60, v61
    v_cvt_pk_bf16_f32 v64, v64, v65
    ds_write2st64_b32 v9, v60, v64 offset0:0 offset1:28
    v_cvt_pk_bf16_f32 v62, v62, v63
    v_cvt_pk_bf16_f32 v66, v66, v67
    ds_write2st64_b32 v9, v62, v66 offset0:14 offset1:42
    v_cndmask_b32_e64 v56, v38, v26, s[66:67]
    v_cndmask_b32_e64 v57, v26, v30, s[66:67]
    v_cndmask_b32_e64 v58, v30, v34, s[66:67]
    v_cndmask_b32_e64 v59, v34, v38, s[66:67]
    s_add_u32 s84, s69, 126976
    buffer_load_dwordx4 a[76:79], v6, s[44:47], s84 offen offset:0 sc1
    v_lshlrev_b32 v40, 16, v56
    v_and_b32 v41, s3, v56
    v_lshlrev_b32 v42, 16, v57
    v_and_b32 v43, s3, v57
    v_lshlrev_b32 v44, 16, v58
    v_and_b32 v45, s3, v58
    v_lshlrev_b32 v46, 16, v59
    v_and_b32 v47, s3, v59
    v_pk_add_f32 v[48:49], v[40:41], v[44:45]
    v_pk_add_f32 v[50:51], v[40:41], v[44:45] neg_lo:[0,1] neg_hi:[0,1]
    v_pk_add_f32 v[52:53], v[42:43], v[46:47]
    v_pk_add_f32 v[54:55], v[42:43], v[46:47] neg_lo:[0,1] neg_hi:[0,1]
    v_pk_add_f32 v[40:41], v[48:49], v[52:53]
    v_pk_add_f32 v[44:45], v[48:49], v[52:53] neg_lo:[0,1] neg_hi:[0,1]
    v_pk_add_f32 v[42:43], v[50:51], v[54:55] op_sel:[0,1] op_sel_hi:[1,0] neg_lo:[0,1]
    v_pk_add_f32 v[46:47], v[50:51], v[54:55] op_sel:[0,1] op_sel_hi:[1,0] neg_hi:[0,1]
    v_cvt_pk_bf16_f32 v40, v40, v41
    v_cvt_pk_bf16_f32 v44, v44, v45
    ds_write2st64_b32 v10, v40, v44 offset0:0 offset1:28
    s_add_u32 s84, s69, 163840
    buffer_load_dwordx4 a[80:83], v6, s[44:47], s84 offen offset:0 sc1
    v_cvt_pk_bf16_f32 v42, v42, v43
    v_cvt_pk_bf16_f32 v46, v46, v47
    ds_write2st64_b32 v10, v42, v46 offset0:14 offset1:42
    s_waitcnt lgkmcnt(0)
    s_barrier
    buffer_load_dwordx4 a[84:87], v6, s[44:47], s84 offen offset:1024 sc1
    ds_read_b128 v[24:27], v11 offset:0
    buffer_load_dwordx4 a[88:91], v6, s[44:47], s84 offen offset:2048 sc1
    ds_read_b128 v[28:31], v11 offset:32
    ds_read_b128 v[32:35], v11 offset:64
    ds_read_b128 v[36:39], v11 offset:96
    s_waitcnt lgkmcnt(3)
    v_mfma_f32_32x32x16_bf16 v[40:55], v[24:27], v[100:103], 0
    buffer_load_dwordx4 a[92:95], v6, s[44:47], s84 offen offset:3072 sc1
    v_mfma_f32_32x32x16_bf16 v[56:71], v[24:27], v[116:119], 0
    s_add_u32 s84, s69, 167936
    buffer_load_dwordx4 a[96:99], v6, s[44:47], s84 offen offset:0 sc1
    s_waitcnt lgkmcnt(2)
    v_mfma_f32_32x32x16_bf16 v[40:55], v[28:31], v[104:107], v[40:55]
    v_mfma_f32_32x32x16_bf16 v[56:71], v[28:31], v[120:123], v[56:71]
    s_add_u32 s84, s69, 245760
    buffer_load_dwordx4 a[120:123], v6, s[44:47], s84 offen offset:0 sc1
    s_waitcnt lgkmcnt(1)
    v_mfma_f32_32x32x16_bf16 v[40:55], v[32:35], v[108:111], v[40:55]
    v_mfma_f32_32x32x16_bf16 v[56:71], v[32:35], v[124:127], v[56:71]
    buffer_load_dwordx4 a[124:127], v6, s[44:47], s84 offen offset:1024 sc1
    s_waitcnt lgkmcnt(0)
    v_mfma_f32_32x32x16_bf16 v[40:55], v[36:39], v[112:115], v[40:55]
    buffer_load_dwordx4 a[128:131], v6, s[44:47], s84 offen offset:2048 sc1
    v_mfma_f32_32x32x16_bf16 v[56:71], v[36:39], v[128:131], v[56:71]
    s_nop 11
    v_cvt_pk_bf16_f32 v72, v40, v56
    v_cvt_pk_bf16_f32 v73, v41, v57
    v_cvt_pk_bf16_f32 v74, v42, v58
    v_cvt_pk_bf16_f32 v75, v43, v59
    s_nop 1
    v_mfma_f32_32x32x16_bf16 v[100:115], v[132:135], v[72:75], 0
    buffer_load_dwordx4 a[132:135], v6, s[44:47], s84 offen offset:3072 sc1
    v_cvt_pk_bf16_f32 v76, v44, v60
    v_cvt_pk_bf16_f32 v77, v45, v61
    v_cvt_pk_bf16_f32 v78, v46, v62
    v_cvt_pk_bf16_f32 v79, v47, v63
    s_nop 1
    v_mfma_f32_32x32x16_bf16 v[100:115], v[136:139], v[76:79], v[100:115]
    s_add_u32 s84, s69, 249856
    buffer_load_dwordx4 a[136:139], v6, s[44:47], s84 offen offset:0 sc1
    v_cvt_pk_bf16_f32 v80, v48, v64
    v_cvt_pk_bf16_f32 v81, v49, v65
    v_cvt_pk_bf16_f32 v82, v50, v66
    v_cvt_pk_bf16_f32 v83, v51, v67
    s_nop 1
    v_mfma_f32_32x32x16_bf16 v[100:115], v[140:143], v[80:83], v[100:115]
    s_add_u32 s84, s69, 286720
    buffer_load_dwordx4 a[140:143], v6, s[44:47], s84 offen offset:0 sc1
    v_mfma_f32_32x32x16_bf16 v[116:131], v[144:147], v[72:75], 0
    s_nop 4
    v_mfma_f32_32x32x16_bf16 v[116:131], v[148:151], v[76:79], v[116:131]
    buffer_load_dwordx4 a[144:147], v6, s[44:47], s84 offen offset:1024 sc1
    s_nop 4
    v_mfma_f32_32x32x16_bf16 v[116:131], v[152:155], v[80:83], v[116:131]
    v_cvt_pk_bf16_f32 v24, v100, v101
    v_cvt_pk_bf16_f32 v25, v102, v103
    ds_write2st64_b32 v12, v24, v25 offset0:0 offset1:10
    buffer_load_dwordx4 a[148:151], v6, s[44:47], s84 offen offset:2048 sc1
    v_cvt_pk_bf16_f32 v26, v104, v105
    v_cvt_pk_bf16_f32 v27, v106, v107
    ds_write2st64_b32 v13, v26, v27 offset0:0 offset1:10
    v_cvt_pk_bf16_f32 v28, v108, v109
    v_cvt_pk_bf16_f32 v29, v110, v111
    ds_write2st64_b32 v14, v28, v29 offset0:0 offset1:10
    v_cvt_pk_bf16_f32 v30, v112, v113
    v_cvt_pk_bf16_f32 v31, v114, v115
    ds_write2st64_b32 v15, v30, v31 offset0:0 offset1:10
    v_cvt_pk_bf16_f32 v32, v116, v117
    buffer_load_dwordx4 a[152:155], v6, s[44:47], s84 offen offset:3072 sc1
    v_cvt_pk_bf16_f32 v33, v118, v119
    ds_write2st64_b32 v16, v32, v33 offset0:0 offset1:10
    s_waitcnt lgkmcnt(0)
    s_barrier
    s_add_u32 s84, s69, 290816
    buffer_load_dwordx4 a[156:159], v6, s[44:47], s84 offen offset:0 sc1
    ds_read_b128 v[40:43], v84 offset:0
    s_add_u32 s84, s69, 368640
    buffer_load_dwordx4 a[180:183], v6, s[44:47], s84 offen offset:0 sc1
    ds_read_b128 v[44:47], v92 offset:0
    ds_read_b128 v[48:51], v84 offset:1024
    ds_read_b128 v[52:55], v92 offset:1024
    ds_read_b128 v[56:59], v85 offset:2048
    s_waitcnt lgkmcnt(4)
    v_perm_b32 v40, v40, v40, v86
    buffer_load_dwordx4 a[184:187], v6, s[44:47], s84 offen offset:1024 sc1
    v_perm_b32 v41, v41, v41, v86
    v_pk_fma_f32 v[40:41], v[40:41], v[176:177], v[156:157]
    v_perm_b32 v42, v42, v42, v86
    v_perm_b32 v43, v43, v43, v86
    v_pk_fma_f32 v[42:43], v[42:43], v[178:179], v[158:159]
    s_waitcnt lgkmcnt(3)
    v_perm_b32 v44, v44, v44, v86
    v_perm_b32 v45, v45, v45, v86
    v_pk_fma_f32 v[44:45], v[44:45], v[180:181], v[160:161]
    v_perm_b32 v46, v46, v46, v86
    v_perm_b32 v47, v47, v47, v86
    v_pk_fma_f32 v[46:47], v[46:47], v[182:183], v[162:163]
    s_waitcnt lgkmcnt(2)
    v_perm_b32 v48, v48, v48, v86
    v_perm_b32 v49, v49, v49, v86
    v_pk_fma_f32 v[48:49], v[48:49], v[184:185], v[164:165]
    v_perm_b32 v50, v50, v50, v86
    v_perm_b32 v51, v51, v51, v86
    v_pk_fma_f32 v[50:51], v[50:51], v[186:187], v[166:167]
    s_waitcnt lgkmcnt(1)
    v_perm_b32 v52, v52, v52, v86
    v_perm_b32 v53, v53, v53, v86
    v_pk_fma_f32 v[52:53], v[52:53], v[188:189], v[168:169]
    v_perm_b32 v54, v54, v54, v86
    buffer_load_dwordx4 a[188:191], v6, s[44:47], s84 offen offset:2048 sc1
    v_perm_b32 v55, v55, v55, v86
    v_pk_fma_f32 v[54:55], v[54:55], v[190:191], v[170:171]
    s_waitcnt lgkmcnt(0)
    v_perm_b32 v56, v56, v56, v86
    v_perm_b32 v57, v57, v57, v86
    v_pk_fma_f32 v[56:57], v[56:57], v[192:193], v[172:173]
    v_perm_b32 v58, v58, v58, v86
    v_perm_b32 v59, v59, v59, v86
    v_pk_fma_f32 v[58:59], v[58:59], v[194:195], v[174:175]
    v_pk_add_f32 v[18:19], v[40:41], v[42:43]
    v_pk_mul_f32 v[20:21], v[40:41], v[40:41]
    v_pk_fma_f32 v[20:21], v[42:43], v[42:43], v[20:21]
    v_pk_add_f32 v[18:19], v[18:19], v[44:45]
    v_pk_fma_f32 v[20:21], v[44:45], v[44:45], v[20:21]
    v_pk_add_f32 v[18:19], v[18:19], v[46:47]
    v_pk_fma_f32 v[20:21], v[46:47], v[46:47], v[20:21]
    v_pk_add_f32 v[18:19], v[18:19], v[48:49]
    v_pk_fma_f32 v[20:21], v[48:49], v[48:49], v[20:21]
    v_pk_add_f32 v[18:19], v[18:19], v[50:51]
    v_pk_fma_f32 v[20:21], v[50:51], v[50:51], v[20:21]
    v_pk_add_f32 v[18:19], v[18:19], v[52:53]
    buffer_load_dwordx4 a[192:195], v6, s[44:47], s84 offen offset:3072 sc1
    v_pk_fma_f32 v[20:21], v[52:53], v[52:53], v[20:21]
    v_pk_add_f32 v[18:19], v[18:19], v[54:55]
    v_pk_fma_f32 v[20:21], v[54:55], v[54:55], v[20:21]
    v_pk_add_f32 v[18:19], v[18:19], v[56:57]
    v_pk_fma_f32 v[20:21], v[56:57], v[56:57], v[20:21]
    v_pk_add_f32 v[18:19], v[18:19], v[58:59]
    v_pk_fma_f32 v[20:21], v[58:59], v[58:59], v[20:21]
    v_add_f32 v18, v18, v19
    v_add_f32 v20, v20, v21
    v_cvt_pk_bf16_f32 v72, v40, v41
    s_nop 0
    v_permlane16_swap_b32 v18, v20
    v_cvt_pk_bf16_f32 v73, v42, v43
    v_add_f32 v18, v18, v20
    v_cvt_pk_bf16_f32 v74, v44, v45
    s_nop 0
    v_add_f32_dpp v18, v18, v18 row_ror:8 row_mask:0xf bank_mask:0xf
    v_cvt_pk_bf16_f32 v75, v46, v47
    s_nop 0
    v_add_f32_dpp v18, v18, v18 row_ror:4 row_mask:0xf bank_mask:0xf
    v_cvt_pk_bf16_f32 v76, v48, v49
    s_nop 0
    v_add_f32_dpp v18, v18, v18 row_ror:2 row_mask:0xf bank_mask:0xf
    v_cvt_pk_bf16_f32 v77, v50, v51
    s_add_u32 s84, s69, 372736
    buffer_load_dwordx4 a[196:199], v6, s[44:47], s84 offen offset:0 sc1
    v_add_f32_dpp v18, v18, v18 row_ror:1 row_mask:0xf bank_mask:0xf
    v_cvt_pk_bf16_f32 v78, v52, v53
    v_mul_f32 v19, 0x3acccccd, v18
    v_cvt_pk_bf16_f32 v79, v54, v55
    v_mul_f32 v20, 0x3acccccd, v18
    v_cvt_pk_bf16_f32 v80, v56, v57
    s_nop 0
    v_permlane16_swap_b32 v19, v20
    v_cvt_pk_bf16_f32 v81, v58, v59
    v_fma_f32 v18, -v19, v19, v20
    v_max_f32 v18, 0, v18
    v_add_f32 v18, 0x3727c5ac, v18
    v_rsq_f32 v18, v18
    s_nop 0
    v_mul_f32 v19, v19, v18
    buffer_store_dwordx4 v[72:75], v87, s[40:43], s83 offen sc1
    v_pk_fma_f32 v[40:41], v[40:41], v[18:19], v[18:19] op_sel:[0,0,1] op_sel_hi:[1,0,1] neg_lo:[0,0,1] neg_hi:[0,0,1]
    v_pk_fma_f32 v[40:41], v[40:41], v[216:217], v[196:197]
    v_pk_fma_f32 v[42:43], v[42:43], v[18:19], v[18:19] op_sel:[0,0,1] op_sel_hi:[1,0,1] neg_lo:[0,0,1] neg_hi:[0,0,1]
    v_pk_fma_f32 v[42:43], v[42:43], v[218:219], v[198:199]
    v_pk_fma_f32 v[44:45], v[44:45], v[18:19], v[18:19] op_sel:[0,0,1] op_sel_hi:[1,0,1] neg_lo:[0,0,1] neg_hi:[0,0,1]
    v_pk_fma_f32 v[44:45], v[44:45], v[220:221], v[200:201]
    v_pk_fma_f32 v[46:47], v[46:47], v[18:19], v[18:19] op_sel:[0,0,1] op_sel_hi:[1,0,1] neg_lo:[0,0,1] neg_hi:[0,0,1]
    v_pk_fma_f32 v[46:47], v[46:47], v[222:223], v[202:203]
    v_pk_fma_f32 v[48:49], v[48:49], v[18:19], v[18:19] op_sel:[0,0,1] op_sel_hi:[1,0,1] neg_lo:[0,0,1] neg_hi:[0,0,1]
    v_pk_fma_f32 v[48:49], v[48:49], v[224:225], v[204:205]
    v_pk_fma_f32 v[50:51], v[50:51], v[18:19], v[18:19] op_sel:[0,0,1] op_sel_hi:[1,0,1] neg_lo:[0,0,1] neg_hi:[0,0,1]
    v_pk_fma_f32 v[50:51], v[50:51], v[226:227], v[206:207]
    v_pk_fma_f32 v[52:53], v[52:53], v[18:19], v[18:19] op_sel:[0,0,1] op_sel_hi:[1,0,1] neg_lo:[0,0,1] neg_hi:[0,0,1]
    v_pk_fma_f32 v[52:53], v[52:53], v[228:229], v[208:209]
    v_pk_fma_f32 v[54:55], v[54:55], v[18:19], v[18:19] op_sel:[0,0,1] op_sel_hi:[1,0,1] neg_lo:[0,0,1] neg_hi:[0,0,1]
    v_pk_fma_f32 v[54:55], v[54:55], v[230:231], v[210:211]
    v_pk_fma_f32 v[56:57], v[56:57], v[18:19], v[18:19] op_sel:[0,0,1] op_sel_hi:[1,0,1] neg_lo:[0,0,1] neg_hi:[0,0,1]
    v_pk_fma_f32 v[56:57], v[56:57], v[232:233], v[212:213]
    v_pk_fma_f32 v[58:59], v[58:59], v[18:19], v[18:19] op_sel:[0,0,1] op_sel_hi:[1,0,1] neg_lo:[0,0,1] neg_hi:[0,0,1]
    v_pk_fma_f32 v[58:59], v[58:59], v[234:235], v[214:215]
    v_pk_add_f32 v[18:19], v[40:41], v[42:43]
    v_pk_mul_f32 v[20:21], v[40:41], v[40:41]
    v_pk_fma_f32 v[20:21], v[42:43], v[42:43], v[20:21]
    v_pk_add_f32 v[18:19], v[18:19], v[44:45]
    v_pk_fma_f32 v[20:21], v[44:45], v[44:45], v[20:21]
    v_pk_add_f32 v[18:19], v[18:19], v[46:47]
    v_pk_fma_f32 v[20:21], v[46:47], v[46:47], v[20:21]
    v_pk_add_f32 v[18:19], v[18:19], v[48:49]
    v_pk_fma_f32 v[20:21], v[48:49], v[48:49], v[20:21]
    v_pk_add_f32 v[18:19], v[18:19], v[50:51]
    buffer_store_dwordx4 v[76:79], v87, s[40:43], s83 offen offset:512 sc1
    v_pk_fma_f32 v[20:21], v[50:51], v[50:51], v[20:21]
    v_pk_add_f32 v[18:19], v[18:19], v[52:53]
    v_pk_fma_f32 v[20:21], v[52:53], v[52:53], v[20:21]
    v_pk_add_f32 v[18:19], v[18:19], v[54:55]
    v_pk_fma_f32 v[20:21], v[54:55], v[54:55], v[20:21]
    v_pk_add_f32 v[18:19], v[18:19], v[56:57]
    v_pk_fma_f32 v[20:21], v[56:57], v[56:57], v[20:21]
    v_pk_add_f32 v[18:19], v[18:19], v[58:59]
    v_pk_fma_f32 v[20:21], v[58:59], v[58:59], v[20:21]
    v_add_f32 v18, v18, v19
    v_add_f32 v20, v20, v21
    s_nop 1
    v_permlane16_swap_b32 v18, v20
    v_add_f32 v18, v18, v20
    s_nop 1
    v_add_f32_dpp v18, v18, v18 row_ror:8 row_mask:0xf bank_mask:0xf
    s_nop 1
    v_add_f32_dpp v18, v18, v18 row_ror:4 row_mask:0xf bank_mask:0xf
    s_nop 1
    v_add_f32_dpp v18, v18, v18 row_ror:2 row_mask:0xf bank_mask:0xf
    s_nop 1
    v_add_f32_dpp v18, v18, v18 row_ror:1 row_mask:0xf bank_mask:0xf
    v_mul_f32 v19, 0x3acccccd, v18
    v_mul_f32 v20, 0x3acccccd, v18
    s_nop 1
    v_permlane16_swap_b32 v19, v20
    v_fma_f32 v18, -v19, v19, v20
    v_max_f32 v18, 0, v18
    v_fmamk_f32 v18, v18, 0x4091afa4, v22
    v_rsq_f32 v18, v18
    s_nop 0
    v_mul_f32 v19, v19, v18
    v_pk_fma_f32 v[40:41], v[40:41], v[18:19], v[18:19] op_sel:[0,0,1] op_sel_hi:[1,0,1] neg_lo:[0,0,1] neg_hi:[0,0,1]
    buffer_store_dwordx2 v[80:81], v88, s[40:43], s83 offen offset:1024 sc1
    v_cvt_pk_bf16_f32 v60, v40, v41
    v_pk_fma_f32 v[42:43], v[42:43], v[18:19], v[18:19] op_sel:[0,0,1] op_sel_hi:[1,0,1] neg_lo:[0,0,1] neg_hi:[0,0,1]
    v_cvt_pk_bf16_f32 v61, v42, v43
    v_pk_fma_f32 v[44:45], v[44:45], v[18:19], v[18:19] op_sel:[0,0,1] op_sel_hi:[1,0,1] neg_lo:[0,0,1] neg_hi:[0,0,1]
    v_cvt_pk_bf16_f32 v62, v44, v45
    v_pk_fma_f32 v[46:47], v[46:47], v[18:19], v[18:19] op_sel:[0,0,1] op_sel_hi:[1,0,1] neg_lo:[0,0,1] neg_hi:[0,0,1]
    v_cvt_pk_bf16_f32 v63, v46, v47
    ds_write_b128 v89, v[60:63]
    v_pk_fma_f32 v[48:49], v[48:49], v[18:19], v[18:19] op_sel:[0,0,1] op_sel_hi:[1,0,1] neg_lo:[0,0,1] neg_hi:[0,0,1]
    v_cvt_pk_bf16_f32 v64, v48, v49
    v_pk_fma_f32 v[50:51], v[50:51], v[18:19], v[18:19] op_sel:[0,0,1] op_sel_hi:[1,0,1] neg_lo:[0,0,1] neg_hi:[0,0,1]
    v_cvt_pk_bf16_f32 v65, v50, v51
    v_pk_fma_f32 v[52:53], v[52:53], v[18:19], v[18:19] op_sel:[0,0,1] op_sel_hi:[1,0,1] neg_lo:[0,0,1] neg_hi:[0,0,1]
    v_cvt_pk_bf16_f32 v66, v52, v53
    v_pk_fma_f32 v[54:55], v[54:55], v[18:19], v[18:19] op_sel:[0,0,1] op_sel_hi:[1,0,1] neg_lo:[0,0,1] neg_hi:[0,0,1]
    v_cvt_pk_bf16_f32 v67, v54, v55
    ds_write_b128 v89, v[64:67] offset:4096
    v_pk_fma_f32 v[56:57], v[56:57], v[18:19], v[18:19] op_sel:[0,0,1] op_sel_hi:[1,0,1] neg_lo:[0,0,1] neg_hi:[0,0,1]
    v_cvt_pk_bf16_f32 v68, v56, v57
    v_pk_fma_f32 v[58:59], v[58:59], v[18:19], v[18:19] op_sel:[0,0,1] op_sel_hi:[1,0,1] neg_lo:[0,0,1] neg_hi:[0,0,1]
    v_cvt_pk_bf16_f32 v69, v58, v59
    ds_write_b64 v90, v[68:69]
    s_waitcnt vmcnt(27)
    s_waitcnt lgkmcnt(0)
    s_barrier
    ds_read_b128 v[24:27], v91 offset:0
    ds_read_b128 v[28:31], v91 offset:4096
    ds_read_b128 v[32:35], v91 offset:8192
    s_waitcnt lgkmcnt(2)
    buffer_store_dwordx4 v[24:27], v6, s[44:47], s80 offen
    s_waitcnt lgkmcnt(1)
    buffer_store_dwordx4 v[28:31], v6, s[44:47], s81 offen
    s_waitcnt lgkmcnt(0)
    buffer_store_dwordx4 v[32:35], v6, s[44:47], s82 offen
    s_add_u32 s84, s69, 409600
    buffer_load_dwordx4 a[200:203], v6, s[44:47], s84 offen offset:0 sc1
    s_mov_b32 s58, 144512
    v_lshl_add_u32 v14, v5, 4, s58
    ds_read_b128 v[184:187], v14 offset:0
    ds_read_b128 v[188:191], v14 offset:0
    ds_read_b128 v[192:195], v14 offset:64
    ds_read_b128 v[196:199], v14 offset:64
    ds_read_b128 v[200:203], v14 offset:128
    ds_read_b128 v[204:207], v14 offset:128
    ds_read_b128 v[208:211], v14 offset:192
    ds_read_b128 v[212:215], v14 offset:192
    buffer_load_dwordx4 a[204:207], v6, s[44:47], s84 offen offset:1024 sc1
    ds_read_b128 v[216:219], v14 offset:256
    ds_read_b128 v[220:223], v14 offset:256
    ds_read_b128 v[224:227], v14 offset:320
    ds_read_b128 v[228:231], v14 offset:320
    v_lshrrev_b32 v12, 3, v4
    v_mul_u32_u24 v12, 163840, v12
    v_lshl_add_u32 v12, v5, 7, v12
    v_and_b32 v13, 7, v1
    v_lshl_add_u32 v20, v13, 4, v12
    v_add_u32 v21, 327680, v20
    s_mul_i32 s56, s49, 655360
    s_lshl_b32 s57, s54, 10
    s_add_u32 s56, s56, s57
    s_add_u32 s76, s56, 1048576
    v_lshrrev_b32 v12, 2, v4
    v_lshl_add_u32 v12, v5, 3, v12
    v_lshlrev_b32 v12, 7, v12
    v_and_b32 v13, 3, v1
    v_lshl_add_u32 v12, v13, 3, v12
    v_bfe_u32 v13, v1, 3, 2
    v_lshl_add_u32 v8, v13, 5, v12
    v_xor_b32 v9, 32, v8
    v_xor_b32 v10, 64, v8
    v_xor_b32 v11, 96, v8
    v_add_u32 v254, 61440, v6
    s_cmp_eq_u32 s95, 0
    s_waitcnt vmcnt(2)
    s_cbranch_scc1 L_slow_pub0
    buffer_store_dword v253, v252, s[44:47], s92 offen offset:0
L_join_pub0:
    buffer_load_dword v251, v250, s[44:47], s92 offen offset:0 sc1
    buffer_load_dwordx4 a[208:211], v6, s[44:47], s84 offen offset:2048 sc1
    buffer_load_dwordx4 a[212:215], v6, s[44:47], s84 offen offset:3072 sc1
    s_add_u32 s84, s69, 413696
    buffer_load_dwordx4 a[216:219], v6, s[44:47], s84 offen offset:0 sc1
    s_add_u32 s84, s69, 81920
    buffer_load_dwordx4 a[40:43], v6, s[44:47], s84 offen offset:0 sc1
    buffer_load_dwordx4 a[44:47], v6, s[44:47], s84 offen offset:1024 sc1
    ds_read_b64_tr_b16 v[232:233], v8 offset:0
    ds_read_b64_tr_b16 v[234:235], v8 offset:512
    ds_read_b64_tr_b16 v[236:237], v9 offset:0
    ds_read_b64_tr_b16 v[238:239], v9 offset:512
    ds_read_b64_tr_b16 v[240:241], v10 offset:0
    ds_read_b64_tr_b16 v[242:243], v10 offset:512
L_chk_fl0:
    s_waitcnt vmcnt(5)
    v_cmp_ne_u32 vcc, s50, v251
    s_cbranch_vccnz L_retry_fl0
L_ok_fl0:
    s_cmp_eq_u32 s95, 0
    s_cbranch_scc1 L_slow_acq0
L_join_acq0:
    buffer_load_dwordx4 v[24:27], v20, s[44:47], s76 offen offset:0 sc1
    buffer_load_dwordx4 v[28:31], v21, s[44:47], s76 offen offset:0 sc1
    buffer_load_dwordx4 v[32:35], v20, s[44:47], s76 offen offset:512 sc1
    buffer_load_dwordx4 v[36:39], v21, s[44:47], s76 offen offset:512 sc1
    s_add_u32 s76, s76, 16384
    buffer_load_dwordx4 v[40:43], v20, s[44:47], s76 offen offset:0 sc1
    buffer_load_dwordx4 v[44:47], v21, s[44:47], s76 offen offset:0 sc1
    buffer_load_dwordx4 v[48:51], v20, s[44:47], s76 offen offset:512 sc1
    buffer_load_dwordx4 v[52:55], v21, s[44:47], s76 offen offset:512 sc1
    s_waitcnt vmcnt(7) lgkmcnt(4)
    v_mfma_f32_16x16x32_bf16 v[184:187], v[232:235], v[24:27], v[184:187]
    ds_read_b64_tr_b16 v[244:245], v11 offset:0
    s_waitcnt vmcnt(6)
    v_mfma_f32_16x16x32_bf16 v[188:191], v[232:235], v[28:31], v[188:191]
    ds_read_b64_tr_b16 v[246:247], v11 offset:512
    s_add_u32 s76, s76, 16384
    buffer_load_dwordx4 v[56:59], v20, s[44:47], s76 offen offset:0 sc1
    s_mul_i32 s80, s54, 393216
    s_waitcnt lgkmcnt(4)
    v_mfma_f32_16x16x32_bf16 v[192:195], v[236:239], v[24:27], v[192:195]
    ds_read_b64_tr_b16 v[232:233], v8 offset:4096
    v_mfma_f32_16x16x32_bf16 v[196:199], v[236:239], v[28:31], v[196:199]
    ds_read_b64_tr_b16 v[234:235], v8 offset:4608
    buffer_load_dwordx4 v[60:63], v21, s[44:47], s76 offen offset:0 sc1
    s_add_u32 s80, s80, 10485760
    s_waitcnt lgkmcnt(4)
    v_mfma_f32_16x16x32_bf16 v[200:203], v[240:243], v[24:27], v[200:203]
    ds_read_b64_tr_b16 v[236:237], v9 offset:4096
    v_mfma_f32_16x16x32_bf16 v[204:207], v[240:243], v[28:31], v[204:207]
    ds_read_b64_tr_b16 v[238:239], v9 offset:4608
    s_lshr_b32 s56, s55, 3
    s_waitcnt lgkmcnt(4)
    v_mfma_f32_16x16x32_bf16 v[208:211], v[244:247], v[24:27], v[208:211]
    ds_read_b64_tr_b16 v[240:241], v10 offset:4096
    v_mfma_f32_16x16x32_bf16 v[212:215], v[244:247], v[28:31], v[212:215]
    ds_read_b64_tr_b16 v[242:243], v10 offset:4608
    buffer_load_dwordx4 v[64:67], v20, s[44:47], s76 offen offset:512 sc1
    s_mul_i32 s56, s56, 196608
    s_waitcnt vmcnt(8) lgkmcnt(4)
    v_mfma_f32_16x16x32_bf16 v[184:187], v[232:235], v[32:35], v[184:187]
    ds_read_b64_tr_b16 v[244:245], v11 offset:4096
    s_waitcnt vmcnt(7)
    v_mfma_f32_16x16x32_bf16 v[188:191], v[232:235], v[36:39], v[188:191]
    ds_read_b64_tr_b16 v[246:247], v11 offset:4608
    s_add_u32 s56, s56, s80
    s_waitcnt lgkmcnt(4)
    v_mfma_f32_16x16x32_bf16 v[192:195], v[236:239], v[32:35], v[192:195]
    ds_read_b64_tr_b16 v[232:233], v8 offset:8192
    v_mfma_f32_16x16x32_bf16 v[196:199], v[236:239], v[36:39], v[196:199]
    ds_read_b64_tr_b16 v[234:235], v8 offset:8704
    buffer_load_dwordx4 v[68:71], v21, s[44:47], s76 offen offset:512 sc1
    s_mul_i32 s57, s49, 12288
    s_waitcnt lgkmcnt(4)
    v_mfma_f32_16x16x32_bf16 v[200:203], v[240:243], v[32:35], v[200:203]
    ds_read_b64_tr_b16 v[236:237], v9 offset:8192
    v_mfma_f32_16x16x32_bf16 v[204:207], v[240:243], v[36:39], v[204:207]
    ds_read_b64_tr_b16 v[238:239], v9 offset:8704
    s_add_u32 s56, s56, s57
    s_waitcnt lgkmcnt(4)
    v_mfma_f32_16x16x32_bf16 v[208:211], v[244:247], v[32:35], v[208:211]
    ds_read_b64_tr_b16 v[240:241], v10 offset:8192
    v_mfma_f32_16x16x32_bf16 v[212:215], v[244:247], v[36:39], v[212:215]
    ds_read_b64_tr_b16 v[242:243], v10 offset:8704
    s_add_u32 s76, s76, 16384
    buffer_load_dwordx4 v[72:75], v20, s[44:47], s76 offen offset:0 sc1
    s_mul_i32 s57, s49, 98304
    s_waitcnt vmcnt(8) lgkmcnt(4)
    v_mfma_f32_16x16x32_bf16 v[184:187], v[232:235], v[40:43], v[184:187]
    ds_read_b64_tr_b16 v[244:245], v11 offset:8192
    s_waitcnt vmcnt(7)
    v_mfma_f32_16x16x32_bf16 v[188:191], v[232:235], v[44:47], v[188:191]
    ds_read_b64_tr_b16 v[246:247], v11 offset:8704
    s_waitcnt lgkmcnt(4)
    v_mfma_f32_16x16x32_bf16 v[192:195], v[236:239], v[40:43], v[192:195]
    ds_read_b64_tr_b16 v[232:233], v8 offset:12288
    v_mfma_f32_16x16x32_bf16 v[196:199], v[236:239], v[44:47], v[196:199]
    ds_read_b64_tr_b16 v[234:235], v8 offset:12800
    buffer_load_dwordx4 v[76:79], v21, s[44:47], s76 offen offset:0 sc1
    s_add_u32 s80, s80, s57
    s_waitcnt lgkmcnt(4)
    v_mfma_f32_16x16x32_bf16 v[200:203], v[240:243], v[40:43], v[200:203]
    ds_read_b64_tr_b16 v[236:237], v9 offset:12288
    v_mfma_f32_16x16x32_bf16 v[204:207], v[240:243], v[44:47], v[204:207]
    ds_read_b64_tr_b16 v[238:239], v9 offset:12800
    buffer_load_dwordx4 v[80:83], v20, s[44:47], s76 offen offset:512 sc1
    s_mul_i32 s57, s55, 3072
    s_waitcnt lgkmcnt(4)
    v_mfma_f32_16x16x32_bf16 v[208:211], v[244:247], v[40:43], v[208:211]
    ds_read_b64_tr_b16 v[240:241], v10 offset:12288
    v_mfma_f32_16x16x32_bf16 v[212:215], v[244:247], v[44:47], v[212:215]
    ds_read_b64_tr_b16 v[242:243], v10 offset:12800
    s_add_u32 s80, s80, s57
    s_waitcnt vmcnt(8) lgkmcnt(4)
    v_mfma_f32_16x16x32_bf16 v[184:187], v[232:235], v[48:51], v[184:187]
    ds_read_b64_tr_b16 v[244:245], v11 offset:12288
    s_waitcnt vmcnt(7)
    v_mfma_f32_16x16x32_bf16 v[188:191], v[232:235], v[52:55], v[188:191]
    ds_read_b64_tr_b16 v[246:247], v11 offset:12800
    buffer_load_dwordx4 v[84:87], v21, s[44:47], s76 offen offset:512 sc1
    s_add_u32 s81, s80, 49152
    s_waitcnt lgkmcnt(4)
    v_mfma_f32_16x16x32_bf16 v[192:195], v[236:239], v[48:51], v[192:195]
    ds_read_b64_tr_b16 v[232:233], v8 offset:16384
    v_mfma_f32_16x16x32_bf16 v[196:199], v[236:239], v[52:55], v[196:199]
    ds_read_b64_tr_b16 v[234:235], v8 offset:16896
    v_mov_b32 v22, 0x409d30fc
    s_waitcnt lgkmcnt(4)
    v_mfma_f32_16x16x32_bf16 v[200:203], v[240:243], v[48:51], v[200:203]
    ds_read_b64_tr_b16 v[236:237], v9 offset:16384
    v_mfma_f32_16x16x32_bf16 v[204:207], v[240:243], v[52:55], v[204:207]
    ds_read_b64_tr_b16 v[238:239], v9 offset:16896
    s_add_u32 s76, s76, 16384
    buffer_load_dwordx4 v[88:91], v20, s[44:47], s76 offen offset:0 sc1
    v_add_u32 v18, 4096, v6
    s_waitcnt lgkmcnt(4)
    v_mfma_f32_16x16x32_bf16 v[208:211], v[244:247], v[48:51], v[208:211]
    ds_read_b64_tr_b16 v[240:241], v10 offset:16384
    v_mfma_f32_16x16x32_bf16 v[212:215], v[244:247], v[52:55], v[212:215]
    ds_read_b64_tr_b16 v[242:243], v10 offset:16896
    v_add_u32 v19, 8192, v6
    s_waitcnt vmcnt(8) lgkmcnt(4)
    v_mfma_f32_16x16x32_bf16 v[184:187], v[232:235], v[56:59], v[184:187]
    ds_read_b64_tr_b16 v[244:245], v11 offset:16384
    s_waitcnt vmcnt(7)
    v_mfma_f32_16x16x32_bf16 v[188:191], v[232:235], v[60:63], v[188:191]
    ds_read_b64_tr_b16 v[246:247], v11 offset:16896
    buffer_load_dwordx4 v[92:95], v21, s[44:47], s76 offen offset:0 sc1
    s_lshl_b32 s93, s49, 6
    s_waitcnt lgkmcnt(4)
    v_mfma_f32_16x16x32_bf16 v[192:195], v[236:239], v[56:59], v[192:195]
    ds_read_b64_tr_b16 v[232:233], v8 offset:30720
    v_mfma_f32_16x16x32_bf16 v[196:199], v[236:239], v[60:63], v[196:199]
    ds_read_b64_tr_b16 v[234:235], v8 offset:31232
    s_waitcnt lgkmcnt(4)
    v_mfma_f32_16x16x32_bf16 v[200:203], v[240:243], v[56:59], v[200:203]
    ds_read_b64_tr_b16 v[236:237], v9 offset:30720
    v_mfma_f32_16x16x32_bf16 v[204:207], v[240:243], v[60:63], v[204:207]
    ds_read_b64_tr_b16 v[238:239], v9 offset:31232
    buffer_load_dwordx4 v[96:99], v20, s[44:47], s76 offen offset:512 sc1
    s_and_b32 s63, s55, 8
    s_waitcnt lgkmcnt(4)
    v_mfma_f32_16x16x32_bf16 v[208:211], v[244:247], v[56:59], v[208:211]
    ds_read_b64_tr_b16 v[240:241], v10 offset:30720
    v_mfma_f32_16x16x32_bf16 v[212:215], v[244:247], v[60:63], v[212:215]
    ds_read_b64_tr_b16 v[242:243], v10 offset:31232
    buffer_load_dwordx4 v[100:103], v21, s[44:47], s76 offen offset:512 sc1
    s_add_u32 s93, s93, s63
    s_waitcnt vmcnt(9) lgkmcnt(4)
    v_mfma_f32_16x16x32_bf16 v[184:187], v[232:235], v[64:67], v[184:187]
    ds_read_b64_tr_b16 v[244:245], v11 offset:30720
    s_waitcnt vmcnt(8)
    v_mfma_f32_16x16x32_bf16 v[188:191], v[232:235], v[68:71], v[188:191]
    ds_read_b64_tr_b16 v[246:247], v11 offset:31232
    v_and_b32 v250, 13, v1
    s_waitcnt lgkmcnt(4)
    v_mfma_f32_16x16x32_bf16 v[192:195], v[236:239], v[64:67], v[192:195]
    ds_read_b64_tr_b16 v[232:233], v8 offset:34816
    v_mfma_f32_16x16x32_bf16 v[196:199], v[236:239], v[68:71], v[196:199]
    ds_read_b64_tr_b16 v[234:235], v8 offset:35328
    s_add_u32 s76, s76, 16384
    buffer_load_dwordx4 v[104:107], v20, s[44:47], s76 offen offset:0 sc1
    v_lshl_add_u32 v250, v250, 2, s93
    s_waitcnt lgkmcnt(4)
    v_mfma_f32_16x16x32_bf16 v[200:203], v[240:243], v[64:67], v[200:203]
    ds_read_b64_tr_b16 v[236:237], v9 offset:34816
    v_mfma_f32_16x16x32_bf16 v[204:207], v[240:243], v[68:71], v[204:207]
    ds_read_b64_tr_b16 v[238:239], v9 offset:35328
    v_mul_u32_u24 v23, 336, v4
    s_waitcnt lgkmcnt(4)
    v_mfma_f32_16x16x32_bf16 v[208:211], v[244:247], v[64:67], v[208:211]
    ds_read_b64_tr_b16 v[240:241], v10 offset:34816
    v_mfma_f32_16x16x32_bf16 v[212:215], v[244:247], v[68:71], v[212:215]
    ds_read_b64_tr_b16 v[242:243], v10 offset:35328
    buffer_load_dwordx4 v[108:111], v21, s[44:47], s76 offen offset:0 sc1
    v_lshl_add_u32 v23, v5, 4, v23
    s_waitcnt vmcnt(9) lgkmcnt(4)
    v_mfma_f32_16x16x32_bf16 v[184:187], v[232:235], v[72:75], v[184:187]
    ds_read_b64_tr_b16 v[244:245], v11 offset:34816
    s_waitcnt vmcnt(8)
    v_mfma_f32_16x16x32_bf16 v[188:191], v[232:235], v[76:79], v[188:191]
    ds_read_b64_tr_b16 v[246:247], v11 offset:35328
    s_add_u32 s57, s49, 1
    s_waitcnt lgkmcnt(4)
    v_mfma_f32_16x16x32_bf16 v[192:195], v[236:239], v[72:75], v[192:195]
    ds_read_b64_tr_b16 v[232:233], v8 offset:38912
    v_mfma_f32_16x16x32_bf16 v[196:199], v[236:239], v[76:79], v[196:199]
    ds_read_b64_tr_b16 v[234:235], v8 offset:39424
    buffer_load_dwordx4 v[112:115], v20, s[44:47], s76 offen offset:512 sc1
    s_waitcnt lgkmcnt(4)
    v_mfma_f32_16x16x32_bf16 v[200:203], v[240:243], v[72:75], v[200:203]
    ds_read_b64_tr_b16 v[236:237], v9 offset:38912
    v_mfma_f32_16x16x32_bf16 v[204:207], v[240:243], v[76:79], v[204:207]
    ds_read_b64_tr_b16 v[238:239], v9 offset:39424
    s_and_b32 s57, s57, 3
    s_waitcnt lgkmcnt(4)
    v_mfma_f32_16x16x32_bf16 v[208:211], v[244:247], v[72:75], v[208:211]
    ds_read_b64_tr_b16 v[240:241], v10 offset:38912
    v_mfma_f32_16x16x32_bf16 v[212:215], v[244:247], v[76:79], v[212:215]
    ds_read_b64_tr_b16 v[242:243], v10 offset:39424
    buffer_load_dwordx4 v[116:119], v21, s[44:47], s76 offen offset:512 sc1
    s_mul_i32 s58, s57, 49152
    s_waitcnt vmcnt(9) lgkmcnt(4)
    v_mfma_f32_16x16x32_bf16 v[184:187], v[232:235], v[80:83], v[184:187]
    ds_read_b64_tr_b16 v[244:245], v11 offset:38912
    s_waitcnt vmcnt(8)
    v_mfma_f32_16x16x32_bf16 v[188:191], v[232:235], v[84:87], v[188:191]
    ds_read_b64_tr_b16 v[246:247], v11 offset:39424
    s_add_u32 s76, s76, 16384
    buffer_load_dwordx4 v[120:123], v20, s[44:47], s76 offen offset:0 sc1
    s_add_u32 s72, s56, s58
    s_waitcnt lgkmcnt(4)
    v_mfma_f32_16x16x32_bf16 v[192:195], v[236:239], v[80:83], v[192:195]
    ds_read_b64_tr_b16 v[232:233], v8 offset:43008
    v_mfma_f32_16x16x32_bf16 v[196:199], v[236:239], v[84:87], v[196:199]
    ds_read_b64_tr_b16 v[234:235], v8 offset:43520
    s_mul_i32 s57, s57, 21504
    s_waitcnt lgkmcnt(4)
    v_mfma_f32_16x16x32_bf16 v[200:203], v[240:243], v[80:83], v[200:203]
    ds_read_b64_tr_b16 v[236:237], v9 offset:43008
    v_mfma_f32_16x16x32_bf16 v[204:207], v[240:243], v[84:87], v[204:207]
    ds_read_b64_tr_b16 v[238:239], v9 offset:43520
    buffer_load_dwordx4 v[124:127], v21, s[44:47], s76 offen offset:0 sc1
    s_add_u32 s57, s57, 0
    s_waitcnt lgkmcnt(4)
    v_mfma_f32_16x16x32_bf16 v[208:211], v[244:247], v[80:83], v[208:211]
    ds_read_b64_tr_b16 v[240:241], v10 offset:43008
    v_mfma_f32_16x16x32_bf16 v[212:215], v[244:247], v[84:87], v[212:215]
    ds_read_b64_tr_b16 v[242:243], v10 offset:43520
    v_add_u32 v12, s57, v23
    s_waitcnt vmcnt(9) lgkmcnt(4)
    v_mfma_f32_16x16x32_bf16 v[184:187], v[232:235], v[88:91], v[184:187]
    ds_read_b64_tr_b16 v[244:245], v11 offset:43008
    s_waitcnt vmcnt(8)
    v_mfma_f32_16x16x32_bf16 v[188:191], v[232:235], v[92:95], v[188:191]
    ds_read_b64_tr_b16 v[246:247], v11 offset:43520
    buffer_load_dwordx4 v[128:131], v20, s[44:47], s76 offen offset:512 sc1
    s_add_u32 s57, s49, 2
    s_waitcnt lgkmcnt(4)
    v_mfma_f32_16x16x32_bf16 v[192:195], v[236:239], v[88:91], v[192:195]
    ds_read_b64_tr_b16 v[232:233], v8 offset:47104
    v_mfma_f32_16x16x32_bf16 v[196:199], v[236:239], v[92:95], v[196:199]
    ds_read_b64_tr_b16 v[234:235], v8 offset:47616
    v_add_u32 v8, 61440, v8
    s_and_b32 s57, s57, 3
    s_waitcnt lgkmcnt(4)
    v_mfma_f32_16x16x32_bf16 v[200:203], v[240:243], v[88:91], v[200:203]
    ds_read_b64_tr_b16 v[236:237], v9 offset:47104
    v_mfma_f32_16x16x32_bf16 v[204:207], v[240:243], v[92:95], v[204:207]
    ds_read_b64_tr_b16 v[238:239], v9 offset:47616
    v_add_u32 v9, 61440, v9
    buffer_load_dwordx4 v[132:135], v21, s[44:47], s76 offen offset:512 sc1
    s_waitcnt lgkmcnt(4)
    v_mfma_f32_16x16x32_bf16 v[208:211], v[244:247], v[88:91], v[208:211]
    ds_read_b64_tr_b16 v[240:241], v10 offset:47104
    v_mfma_f32_16x16x32_bf16 v[212:215], v[244:247], v[92:95], v[212:215]
    ds_read_b64_tr_b16 v[242:243], v10 offset:47616
    v_add_u32 v10, 61440, v10
    s_mul_i32 s58, s57, 49152
    s_waitcnt vmcnt(9) lgkmcnt(4)
    v_mfma_f32_16x16x32_bf16 v[184:187], v[232:235], v[96:99], v[184:187]
    ds_read_b64_tr_b16 v[244:245], v11 offset:47104
    s_waitcnt vmcnt(8)
    v_mfma_f32_16x16x32_bf16 v[188:191], v[232:235], v[100:103], v[188:191]
    ds_read_b64_tr_b16 v[246:247], v11 offset:47616
    v_add_u32 v11, 61440, v11
    s_add_u32 s76, s76, 16384
    buffer_load_dwordx4 v[136:139], v20, s[44:47], s76 offen offset:0 sc1
    s_add_u32 s73, s56, s58
    s_waitcnt lgkmcnt(4)
    v_mfma_f32_16x16x32_bf16 v[192:195], v[236:239], v[96:99], v[192:195]
    ds_read_b64_tr_b16 v[232:233], v8 offset:0
    v_mfma_f32_16x16x32_bf16 v[196:199], v[236:239], v[100:103], v[196:199]
    ds_read_b64_tr_b16 v[234:235], v8 offset:512
    buffer_load_dwordx4 v[140:143], v21, s[44:47], s76 offen offset:0 sc1
    s_mul_i32 s57, s57, 21504
    s_waitcnt lgkmcnt(4)
    v_mfma_f32_16x16x32_bf16 v[200:203], v[240:243], v[96:99], v[200:203]
    ds_read_b64_tr_b16 v[236:237], v9 offset:0
    v_mfma_f32_16x16x32_bf16 v[204:207], v[240:243], v[100:103], v[204:207]
    ds_read_b64_tr_b16 v[238:239], v9 offset:512
    s_add_u32 s57, s57, 5376
    s_waitcnt lgkmcnt(4)
    v_mfma_f32_16x16x32_bf16 v[208:211], v[244:247], v[96:99], v[208:211]
    ds_read_b64_tr_b16 v[240:241], v10 offset:0
    v_mfma_f32_16x16x32_bf16 v[212:215], v[244:247], v[100:103], v[212:215]
    ds_read_b64_tr_b16 v[242:243], v10 offset:512
    buffer_load_dwordx4 v[144:147], v20, s[44:47], s76 offen offset:512 sc1
    v_add_u32 v13, s57, v23
    s_waitcnt vmcnt(10) lgkmcnt(4)
    v_mfma_f32_16x16x32_bf16 v[184:187], v[232:235], v[104:107], v[184:187]
    ds_read_b64_tr_b16 v[244:245], v11 offset:0
    s_waitcnt vmcnt(9)
    v_mfma_f32_16x16x32_bf16 v[188:191], v[232:235], v[108:111], v[188:191]
    ds_read_b64_tr_b16 v[246:247], v11 offset:512
    s_add_u32 s57, s49, 3
    s_add_u32 m0, s85, 20480
    s_add_u32 s91, s86, 0
    buffer_load_dwordx4 v6, s[44:47], s91 offen sc1 lds
    s_waitcnt lgkmcnt(4)
    v_mfma_f32_16x16x32_bf16 v[192:195], v[236:239], v[104:107], v[192:195]
    ds_read_b64_tr_b16 v[232:233], v8 offset:4096
    v_mfma_f32_16x16x32_bf16 v[196:199], v[236:239], v[108:111], v[196:199]
    ds_read_b64_tr_b16 v[234:235], v8 offset:4608
    buffer_load_dwordx4 v[148:151], v21, s[44:47], s76 offen offset:512 sc1
    s_and_b32 s57, s57, 3
    s_waitcnt lgkmcnt(4)
    v_mfma_f32_16x16x32_bf16 v[200:203], v[240:243], v[104:107], v[200:203]
    ds_read_b64_tr_b16 v[236:237], v9 offset:4096
    v_mfma_f32_16x16x32_bf16 v[204:207], v[240:243], v[108:111], v[204:207]
    ds_read_b64_tr_b16 v[238:239], v9 offset:4608
    s_mul_i32 s58, s57, 49152
    s_waitcnt lgkmcnt(4)
    v_mfma_f32_16x16x32_bf16 v[208:211], v[244:247], v[104:107], v[208:211]
    ds_read_b64_tr_b16 v[240:241], v10 offset:4096
    v_mfma_f32_16x16x32_bf16 v[212:215], v[244:247], v[108:111], v[212:215]
    ds_read_b64_tr_b16 v[242:243], v10 offset:4608
    s_add_u32 s76, s76, 16384
    buffer_load_dwordx4 v[152:155], v20, s[44:47], s76 offen offset:0 sc1
    s_add_u32 m0, s85, 21504
    s_add_u32 s91, s86, 1024
    buffer_load_dwordx4 v6, s[44:47], s91 offen sc1 lds
    s_waitcnt vmcnt(12) lgkmcnt(4)
    v_mfma_f32_16x16x32_bf16 v[184:187], v[232:235], v[112:115], v[184:187]
    ds_read_b64_tr_b16 v[244:245], v11 offset:4096
    s_waitcnt vmcnt(11)
    v_mfma_f32_16x16x32_bf16 v[188:191], v[232:235], v[116:119], v[188:191]
    ds_read_b64_tr_b16 v[246:247], v11 offset:4608
    s_add_u32 s74, s56, s58
    s_waitcnt lgkmcnt(4)
    v_mfma_f32_16x16x32_bf16 v[192:195], v[236:239], v[112:115], v[192:195]
    ds_read_b64_tr_b16 v[232:233], v8 offset:8192
    v_mfma_f32_16x16x32_bf16 v[196:199], v[236:239], v[116:119], v[196:199]
    ds_read_b64_tr_b16 v[234:235], v8 offset:8704
    buffer_load_dwordx4 v[156:159], v21, s[44:47], s76 offen offset:0 sc1
    s_mul_i32 s57, s57, 21504
    s_waitcnt lgkmcnt(4)
    v_mfma_f32_16x16x32_bf16 v[200:203], v[240:243], v[112:115], v[200:203]
    ds_read_b64_tr_b16 v[236:237], v9 offset:8192
    v_mfma_f32_16x16x32_bf16 v[204:207], v[240:243], v[116:119], v[204:207]
    ds_read_b64_tr_b16 v[238:239], v9 offset:8704
    buffer_load_dwordx4 v[160:163], v20, s[44:47], s76 offen offset:512 sc1
    s_add_u32 s57, s57, 10752
    s_add_u32 m0, s85, 22528
    s_add_u32 s91, s86, 2048
    buffer_load_dwordx4 v6, s[44:47], s91 offen sc1 lds
    s_waitcnt lgkmcnt(4)
    v_mfma_f32_16x16x32_bf16 v[208:211], v[244:247], v[112:115], v[208:211]
    ds_read_b64_tr_b16 v[240:241], v10 offset:8192
    v_mfma_f32_16x16x32_bf16 v[212:215], v[244:247], v[116:119], v[212:215]
    ds_read_b64_tr_b16 v[242:243], v10 offset:8704
    v_add_u32 v14, s57, v23
    s_waitcnt vmcnt(13) lgkmcnt(4)
    v_mfma_f32_16x16x32_bf16 v[184:187], v[232:235], v[120:123], v[184:187]
    ds_read_b64_tr_b16 v[244:245], v11 offset:8192
    s_waitcnt vmcnt(12)
    v_mfma_f32_16x16x32_bf16 v[188:191], v[232:235], v[124:127], v[188:191]
    ds_read_b64_tr_b16 v[246:247], v11 offset:8704
    buffer_load_dwordx4 v[164:167], v21, s[44:47], s76 offen offset:512 sc1
    s_add_u32 s57, s49, 4
    s_waitcnt lgkmcnt(4)
    v_mfma_f32_16x16x32_bf16 v[192:195], v[236:239], v[120:123], v[192:195]
    ds_read_b64_tr_b16 v[232:233], v8 offset:12288
    v_mfma_f32_16x16x32_bf16 v[196:199], v[236:239], v[124:127], v[196:199]
    ds_read_b64_tr_b16 v[234:235], v8 offset:12800
    s_and_b32 s57, s57, 3
    s_add_u32 m0, s85, 23552
    s_add_u32 s91, s86, 3072
    buffer_load_dwordx4 v6, s[44:47], s91 offen sc1 lds
    s_waitcnt lgkmcnt(4)
    v_mfma_f32_16x16x32_bf16 v[200:203], v[240:243], v[120:123], v[200:203]
    ds_read_b64_tr_b16 v[236:237], v9 offset:12288
    v_mfma_f32_16x16x32_bf16 v[204:207], v[240:243], v[124:127], v[204:207]
    ds_read_b64_tr_b16 v[238:239], v9 offset:12800
    s_add_u32 s76, s76, 16384
    buffer_load_dwordx4 v[168:171], v20, s[44:47], s76 offen offset:0 sc1
    s_mul_i32 s58, s57, 49152
    s_waitcnt lgkmcnt(4)
    v_mfma_f32_16x16x32_bf16 v[208:211], v[244:247], v[120:123], v[208:211]
    ds_read_b64_tr_b16 v[240:241], v10 offset:12288
    v_mfma_f32_16x16x32_bf16 v[212:215], v[244:247], v[124:127], v[212:215]
    ds_read_b64_tr_b16 v[242:243], v10 offset:12800
    s_waitcnt vmcnt(14) lgkmcnt(4)
    v_mfma_f32_16x16x32_bf16 v[184:187], v[232:235], v[128:131], v[184:187]
    ds_read_b64_tr_b16 v[244:245], v11 offset:12288
    s_waitcnt vmcnt(13)
    v_mfma_f32_16x16x32_bf16 v[188:191], v[232:235], v[132:135], v[188:191]
    ds_read_b64_tr_b16 v[246:247], v11 offset:12800
    buffer_load_dwordx4 v[172:175], v21, s[44:47], s76 offen offset:0 sc1
    s_add_u32 s75, s56, s58
    s_add_u32 m0, s85, 24576
    s_add_u32 s91, s86, 4096
    buffer_load_dwordx4 v6, s[44:47], s91 offen sc1 lds
    s_waitcnt lgkmcnt(4)
    v_mfma_f32_16x16x32_bf16 v[192:195], v[236:239], v[128:131], v[192:195]
    ds_read_b64_tr_b16 v[232:233], v8 offset:16384
    v_mfma_f32_16x16x32_bf16 v[196:199], v[236:239], v[132:135], v[196:199]
    ds_read_b64_tr_b16 v[234:235], v8 offset:16896
    s_mul_i32 s57, s57, 21504
    s_waitcnt lgkmcnt(4)
    v_mfma_f32_16x16x32_bf16 v[200:203], v[240:243], v[128:131], v[200:203]
    ds_read_b64_tr_b16 v[236:237], v9 offset:16384
    v_mfma_f32_16x16x32_bf16 v[204:207], v[240:243], v[132:135], v[204:207]
    ds_read_b64_tr_b16 v[238:239], v9 offset:16896
    buffer_load_dwordx4 v[176:179], v20, s[44:47], s76 offen offset:512 sc1
    s_add_u32 s57, s57, 16128
    s_waitcnt lgkmcnt(4)
    v_mfma_f32_16x16x32_bf16 v[208:211], v[244:247], v[128:131], v[208:211]
    ds_read_b64_tr_b16 v[240:241], v10 offset:16384
    v_mfma_f32_16x16x32_bf16 v[212:215], v[244:247], v[132:135], v[212:215]
    ds_read_b64_tr_b16 v[242:243], v10 offset:16896
    buffer_load_dwordx4 v[180:183], v21, s[44:47], s76 offen offset:512 sc1
    v_add_u32 v15, s57, v23
    s_add_u32 m0, s85, 25600
    s_add_u32 s91, s86, 5120
    buffer_load_dwordx4 v6, s[44:47], s91 offen sc1 lds
    s_waitcnt vmcnt(17) lgkmcnt(4)
    v_mfma_f32_16x16x32_bf16 v[184:187], v[232:235], v[136:139], v[184:187]
    ds_read_b64_tr_b16 v[244:245], v11 offset:16384
    s_waitcnt vmcnt(16)
    v_mfma_f32_16x16x32_bf16 v[188:191], v[232:235], v[140:143], v[188:191]
    ds_read_b64_tr_b16 v[246:247], v11 offset:16896
    v_lshrrev_b32 v16, 2, v1
    s_waitcnt lgkmcnt(4)
    v_mfma_f32_16x16x32_bf16 v[192:195], v[236:239], v[136:139], v[192:195]
    ds_read_b64_tr_b16 v[232:233], v8 offset:30720
    v_mfma_f32_16x16x32_bf16 v[196:199], v[236:239], v[140:143], v[196:199]
    ds_read_b64_tr_b16 v[234:235], v8 offset:31232
    v_and_b32 v248, 7, v16
    s_waitcnt lgkmcnt(4)
    v_mfma_f32_16x16x32_bf16 v[200:203], v[240:243], v[136:139], v[200:203]
    ds_read_b64_tr_b16 v[236:237], v9 offset:30720
    v_mfma_f32_16x16x32_bf16 v[204:207], v[240:243], v[140:143], v[204:207]
    ds_read_b64_tr_b16 v[238:239], v9 offset:31232
    v_mul_u32_u24 v16, 336, v16
    s_add_u32 m0, s85, 26624
    s_add_u32 s91, s86, 6144
    buffer_load_dwordx4 v6, s[44:47], s91 offen sc1 lds
    s_waitcnt lgkmcnt(4)
    v_mfma_f32_16x16x32_bf16 v[208:211], v[244:247], v[136:139], v[208:211]
    ds_read_b64_tr_b16 v[240:241], v10 offset:30720
    v_mfma_f32_16x16x32_bf16 v[212:215], v[244:247], v[140:143], v[212:215]
    ds_read_b64_tr_b16 v[242:243], v10 offset:31232
    s_mul_i32 s58, s49, 21504
    s_waitcnt vmcnt(16) lgkmcnt(4)
    v_mfma_f32_16x16x32_bf16 v[184:187], v[232:235], v[144:147], v[184:187]
    ds_read_b64_tr_b16 v[244:245], v11 offset:30720
    s_waitcnt vmcnt(14)
    v_mfma_f32_16x16x32_bf16 v[188:191], v[232:235], v[148:151], v[188:191]
    ds_read_b64_tr_b16 v[246:247], v11 offset:31232
    s_waitcnt lgkmcnt(4)
    v_mfma_f32_16x16x32_bf16 v[192:195], v[236:239], v[144:147], v[192:195]
    ds_read_b64_tr_b16 v[232:233], v8 offset:34816
    v_mfma_f32_16x16x32_bf16 v[196:199], v[236:239], v[148:151], v[196:199]
    ds_read_b64_tr_b16 v[234:235], v8 offset:35328
    v_add_u32 v16, s58, v16
    s_add_u32 m0, s85, 27648
    s_add_u32 s91, s86, 7168
    buffer_load_dwordx4 v6, s[44:47], s91 offen sc1 lds
    s_waitcnt lgkmcnt(4)
    v_mfma_f32_16x16x32_bf16 v[200:203], v[240:243], v[144:147], v[200:203]
    ds_read_b64_tr_b16 v[236:237], v9 offset:34816
    v_mfma_f32_16x16x32_bf16 v[204:207], v[240:243], v[148:151], v[204:207]
    ds_read_b64_tr_b16 v[238:239], v9 offset:35328
    v_and_b32 v23, 3, v1
    s_waitcnt lgkmcnt(4)
    v_mfma_f32_16x16x32_bf16 v[208:211], v[244:247], v[144:147], v[208:211]
    ds_read_b64_tr_b16 v[240:241], v10 offset:34816
    v_mfma_f32_16x16x32_bf16 v[212:215], v[244:247], v[148:151], v[212:215]
    ds_read_b64_tr_b16 v[242:243], v10 offset:35328
    v_lshl_add_u32 v17, v23, 4, v16
    s_waitcnt vmcnt(14) lgkmcnt(4)
    v_mfma_f32_16x16x32_bf16 v[184:187], v[232:235], v[152:155], v[184:187]
    ds_read_b64_tr_b16 v[244:245], v11 offset:34816
    s_waitcnt vmcnt(12)
    v_mfma_f32_16x16x32_bf16 v[188:191], v[232:235], v[156:159], v[188:191]
    ds_read_b64_tr_b16 v[246:247], v11 offset:35328
    v_lshl_add_u32 v16, v23, 5, v16
    s_add_u32 m0, s85, 28672
    s_add_u32 s91, s86, 8192
    buffer_load_dwordx4 v6, s[44:47], s91 offen sc1 lds
    s_waitcnt lgkmcnt(4)
    v_mfma_f32_16x16x32_bf16 v[192:195], v[236:239], v[152:155], v[192:195]
    ds_read_b64_tr_b16 v[232:233], v8 offset:38912
    v_mfma_f32_16x16x32_bf16 v[196:199], v[236:239], v[156:159], v[196:199]
    ds_read_b64_tr_b16 v[234:235], v8 offset:39424
    s_and_b32 s56, s48, 0xf8
    s_waitcnt lgkmcnt(4)
    v_mfma_f32_16x16x32_bf16 v[200:203], v[240:243], v[152:155], v[200:203]
    ds_read_b64_tr_b16 v[236:237], v9 offset:38912
    v_mfma_f32_16x16x32_bf16 v[204:207], v[240:243], v[156:159], v[204:207]
    ds_read_b64_tr_b16 v[238:239], v9 offset:39424
    s_lshl_b32 s57, s49, 1
    s_waitcnt lgkmcnt(4)
    v_mfma_f32_16x16x32_bf16 v[208:211], v[244:247], v[152:155], v[208:211]
    ds_read_b64_tr_b16 v[240:241], v10 offset:38912
    v_mfma_f32_16x16x32_bf16 v[212:215], v[244:247], v[156:159], v[212:215]
    ds_read_b64_tr_b16 v[242:243], v10 offset:39424
    s_add_u32 s56, s56, s57
    s_add_u32 m0, s85, 29696
    s_add_u32 s91, s86, 9216
    buffer_load_dwordx4 v6, s[44:47], s91 offen sc1 lds
    s_waitcnt vmcnt(13) lgkmcnt(4)
    v_mfma_f32_16x16x32_bf16 v[184:187], v[232:235], v[160:163], v[184:187]
    ds_read_b64_tr_b16 v[244:245], v11 offset:38912
    s_waitcnt vmcnt(11)
    v_mfma_f32_16x16x32_bf16 v[188:191], v[232:235], v[164:167], v[188:191]
    ds_read_b64_tr_b16 v[246:247], v11 offset:39424
    s_and_b32 s58, s55, 7
    s_waitcnt lgkmcnt(4)
    v_mfma_f32_16x16x32_bf16 v[192:195], v[236:239], v[160:163], v[192:195]
    ds_read_b64_tr_b16 v[232:233], v8 offset:43008
    v_mfma_f32_16x16x32_bf16 v[196:199], v[236:239], v[164:167], v[196:199]
    ds_read_b64_tr_b16 v[234:235], v8 offset:43520
    s_waitcnt lgkmcnt(4)
    v_mfma_f32_16x16x32_bf16 v[200:203], v[240:243], v[160:163], v[200:203]
    ds_read_b64_tr_b16 v[236:237], v9 offset:43008
    v_mfma_f32_16x16x32_bf16 v[204:207], v[240:243], v[164:167], v[204:207]
    ds_read_b64_tr_b16 v[238:239], v9 offset:43520
    s_mul_i32 s59, s58, 160
    buffer_load_dwordx4 a[48:51], v6, s[44:47], s84 offen offset:2048 sc1
    s_waitcnt lgkmcnt(4)
    v_mfma_f32_16x16x32_bf16 v[208:211], v[244:247], v[160:163], v[208:211]
    ds_read_b64_tr_b16 v[240:241], v10 offset:43008
    v_mfma_f32_16x16x32_bf16 v[212:215], v[244:247], v[164:167], v[212:215]
    ds_read_b64_tr_b16 v[242:243], v10 offset:43520
    v_lshlrev_b32 v248, 8, v248
    s_waitcnt vmcnt(10) lgkmcnt(4)
    v_mfma_f32_16x16x32_bf16 v[184:187], v[232:235], v[168:171], v[184:187]
    ds_read_b64_tr_b16 v[244:245], v11 offset:43008
    s_waitcnt vmcnt(9)
    v_mfma_f32_16x16x32_bf16 v[188:191], v[232:235], v[172:175], v[188:191]
    ds_read_b64_tr_b16 v[246:247], v11 offset:43520
    v_add3_u32 v248, v3, v248, s56
    s_waitcnt lgkmcnt(4)
    v_mfma_f32_16x16x32_bf16 v[192:195], v[236:239], v[168:171], v[192:195]
    ds_read_b64_tr_b16 v[232:233], v8 offset:47104
    v_mfma_f32_16x16x32_bf16 v[196:199], v[236:239], v[172:175], v[196:199]
    ds_read_b64_tr_b16 v[234:235], v8 offset:47616
    v_mul_u32_u24 v248, 1280, v248
    buffer_load_dwordx4 a[52:55], v6, s[44:47], s84 offen offset:3072 sc1
    s_waitcnt lgkmcnt(4)
    v_mfma_f32_16x16x32_bf16 v[200:203], v[240:243], v[168:171], v[200:203]
    ds_read_b64_tr_b16 v[236:237], v9 offset:47104
    v_mfma_f32_16x16x32_bf16 v[204:207], v[240:243], v[172:175], v[204:207]
    ds_read_b64_tr_b16 v[238:239], v9 offset:47616
    v_add_u32 v248, s59, v248
    s_waitcnt lgkmcnt(4)
    v_mfma_f32_16x16x32_bf16 v[208:211], v[244:247], v[168:171], v[208:211]
    ds_read_b64_tr_b16 v[240:241], v10 offset:47104
    v_mfma_f32_16x16x32_bf16 v[212:215], v[244:247], v[172:175], v[212:215]
    ds_read_b64_tr_b16 v[242:243], v10 offset:47616
    v_lshl_add_u32 v249, v23, 3, v248
    s_waitcnt vmcnt(8) lgkmcnt(4)
    v_mfma_f32_16x16x32_bf16 v[184:187], v[232:235], v[176:179], v[184:187]
    ds_read_b64_tr_b16 v[244:245], v11 offset:47104
    s_waitcnt vmcnt(7)
    v_mfma_f32_16x16x32_bf16 v[188:191], v[232:235], v[180:183], v[188:191]
    ds_read_b64_tr_b16 v[246:247], v11 offset:47616
    v_lshl_add_u32 v248, v23, 4, v248
    s_add_u32 s84, s69, 86016
    buffer_load_dwordx4 a[56:59], v6, s[44:47], s84 offen offset:0 sc1
    s_waitcnt lgkmcnt(4)
    v_mfma_f32_16x16x32_bf16 v[192:195], v[236:239], v[176:179], v[192:195]
    v_mfma_f32_16x16x32_bf16 v[196:199], v[236:239], v[180:183], v[196:199]
    s_waitcnt lgkmcnt(2)
    v_mfma_f32_16x16x32_bf16 v[200:203], v[240:243], v[176:179], v[200:203]
    v_mfma_f32_16x16x32_bf16 v[204:207], v[240:243], v[180:183], v[204:207]
    s_waitcnt lgkmcnt(0)
    v_mfma_f32_16x16x32_bf16 v[208:211], v[244:247], v[176:179], v[208:211]
    v_mfma_f32_16x16x32_bf16 v[212:215], v[244:247], v[180:183], v[212:215]
    s_add_u32 s84, s69, 204800
    buffer_load_dwordx4 a[100:103], v6, s[44:47], s84 offen offset:0 sc1
    v_pk_fma_f32 v[232:233], v[184:185], v[184:185], v[22:23] op_sel_hi:[1,1,0]
    v_pk_fma_f32 v[234:235], v[186:187], v[186:187], v[22:23] op_sel_hi:[1,1,0]
    v_pk_fma_f32 v[236:237], v[192:193], v[192:193], v[22:23] op_sel_hi:[1,1,0]
    v_pk_fma_f32 v[238:239], v[194:195], v[194:195], v[22:23] op_sel_hi:[1,1,0]
    v_pk_mul_f32 v[232:233], v[232:233], v[184:185] neg_lo:[0,1] neg_hi:[0,1]
    v_pk_mul_f32 v[234:235], v[234:235], v[186:187] neg_lo:[0,1] neg_hi:[0,1]
    v_pk_mul_f32 v[236:237], v[236:237], v[192:193] neg_lo:[0,1] neg_hi:[0,1]
    v_pk_mul_f32 v[238:239], v[238:239], v[194:195] neg_lo:[0,1] neg_hi:[0,1]
    v_exp_f32 v232, v232
    v_exp_f32 v233, v233
    v_exp_f32 v234, v234
    v_exp_f32 v235, v235
    v_exp_f32 v236, v236
    v_exp_f32 v237, v237
    v_exp_f32 v238, v238
    v_exp_f32 v239, v239
    v_pk_add_f32 v[232:233], v[232:233], 1.0 op_sel_hi:[1,0]
    v_pk_add_f32 v[234:235], v[234:235], 1.0 op_sel_hi:[1,0]
    v_pk_add_f32 v[236:237], v[236:237], 1.0 op_sel_hi:[1,0]
    v_pk_add_f32 v[238:239], v[238:239], 1.0 op_sel_hi:[1,0]
    v_rcp_f32 v232, v232
    v_rcp_f32 v233, v233
    buffer_load_dwordx4 a[104:107], v6, s[44:47], s84 offen offset:1024 sc1
    v_rcp_f32 v234, v234
    v_rcp_f32 v235, v235
    v_rcp_f32 v236, v236
    v_rcp_f32 v237, v237
    v_rcp_f32 v238, v238
    v_rcp_f32 v239, v239
    v_pk_mul_f32 v[232:233], v[232:233], v[184:185]
    v_pk_mul_f32 v[234:235], v[234:235], v[186:187]
    v_pk_mul_f32 v[236:237], v[236:237], v[192:193]
    v_pk_mul_f32 v[238:239], v[238:239], v[194:195]
    v_cvt_pk_bf16_f32 v240, v232, v233
    v_cvt_pk_bf16_f32 v241, v234, v235
    v_cvt_pk_bf16_f32 v242, v236, v237
    v_cvt_pk_bf16_f32 v243, v238, v239
    buffer_store_dwordx4 v[240:243], v6, s[44:47], s80 offen offset:0 sc1
    v_pk_fma_f32 v[232:233], v[188:189], v[188:189], v[22:23] op_sel_hi:[1,1,0]
    v_pk_fma_f32 v[234:235], v[190:191], v[190:191], v[22:23] op_sel_hi:[1,1,0]
    v_pk_fma_f32 v[236:237], v[196:197], v[196:197], v[22:23] op_sel_hi:[1,1,0]
    v_pk_fma_f32 v[238:239], v[198:199], v[198:199], v[22:23] op_sel_hi:[1,1,0]
    v_pk_mul_f32 v[232:233], v[232:233], v[188:189] neg_lo:[0,1] neg_hi:[0,1]
    v_pk_mul_f32 v[234:235], v[234:235], v[190:191] neg_lo:[0,1] neg_hi:[0,1]
    v_pk_mul_f32 v[236:237], v[236:237], v[196:197] neg_lo:[0,1] neg_hi:[0,1]
    v_pk_mul_f32 v[238:239], v[238:239], v[198:199] neg_lo:[0,1] neg_hi:[0,1]
    buffer_load_dwordx4 a[108:111], v6, s[44:47], s84 offen offset:2048 sc1
    v_exp_f32 v232, v232
    v_exp_f32 v233, v233
    v_exp_f32 v234, v234
    v_exp_f32 v235, v235
    v_exp_f32 v236, v236
    v_exp_f32 v237, v237
    v_exp_f32 v238, v238
    v_exp_f32 v239, v239
    v_pk_add_f32 v[232:233], v[232:233], 1.0 op_sel_hi:[1,0]
    v_pk_add_f32 v[234:235], v[234:235], 1.0 op_sel_hi:[1,0]
    v_pk_add_f32 v[236:237], v[236:237], 1.0 op_sel_hi:[1,0]
    v_pk_add_f32 v[238:239], v[238:239], 1.0 op_sel_hi:[1,0]
    v_rcp_f32 v232, v232
    v_rcp_f32 v233, v233
    v_rcp_f32 v234, v234
    v_rcp_f32 v235, v235
    v_rcp_f32 v236, v236
    buffer_load_dwordx4 a[112:115], v6, s[44:47], s84 offen offset:3072 sc1
    v_rcp_f32 v237, v237
    v_rcp_f32 v238, v238
    v_rcp_f32 v239, v239
    v_pk_mul_f32 v[232:233], v[232:233], v[188:189]
    v_pk_mul_f32 v[234:235], v[234:235], v[190:191]
    v_pk_mul_f32 v[236:237], v[236:237], v[196:197]
    v_pk_mul_f32 v[238:239], v[238:239], v[198:199]
    v_cvt_pk_bf16_f32 v244, v232, v233
    v_cvt_pk_bf16_f32 v245, v234, v235
    v_cvt_pk_bf16_f32 v246, v236, v237
    v_cvt_pk_bf16_f32 v247, v238, v239
    buffer_store_dwordx4 v[244:247], v6, s[44:47], s81 offen offset:0 sc1
    v_pk_fma_f32 v[184:185], v[200:201], v[200:201], v[22:23] op_sel_hi:[1,1,0]
    v_pk_fma_f32 v[186:187], v[202:203], v[202:203], v[22:23] op_sel_hi:[1,1,0]
    v_pk_fma_f32 v[188:189], v[208:209], v[208:209], v[22:23] op_sel_hi:[1,1,0]
    v_pk_fma_f32 v[190:191], v[210:211], v[210:211], v[22:23] op_sel_hi:[1,1,0]
    v_pk_mul_f32 v[184:185], v[184:185], v[200:201] neg_lo:[0,1] neg_hi:[0,1]
    v_pk_mul_f32 v[186:187], v[186:187], v[202:203] neg_lo:[0,1] neg_hi:[0,1]
    v_pk_mul_f32 v[188:189], v[188:189], v[208:209] neg_lo:[0,1] neg_hi:[0,1]
    v_pk_mul_f32 v[190:191], v[190:191], v[210:211] neg_lo:[0,1] neg_hi:[0,1]
    v_exp_f32 v184, v184
    v_exp_f32 v185, v185
    v_exp_f32 v186, v186
    v_exp_f32 v187, v187
    s_add_u32 s84, s69, 208896
    buffer_load_dwordx4 a[116:119], v6, s[44:47], s84 offen offset:0 sc1
    v_exp_f32 v188, v188
    v_exp_f32 v189, v189
    v_exp_f32 v190, v190
    v_exp_f32 v191, v191
    v_pk_add_f32 v[184:185], v[184:185], 1.0 op_sel_hi:[1,0]
    v_pk_add_f32 v[186:187], v[186:187], 1.0 op_sel_hi:[1,0]
    v_pk_add_f32 v[188:189], v[188:189], 1.0 op_sel_hi:[1,0]
    v_pk_add_f32 v[190:191], v[190:191], 1.0 op_sel_hi:[1,0]
    v_rcp_f32 v184, v184
    v_rcp_f32 v185, v185
    v_rcp_f32 v186, v186
    v_rcp_f32 v187, v187
    v_rcp_f32 v188, v188
    v_rcp_f32 v189, v189
    v_rcp_f32 v190, v190
    v_rcp_f32 v191, v191
    v_pk_mul_f32 v[184:185], v[184:185], v[200:201]
    v_pk_mul_f32 v[186:187], v[186:187], v[202:203]
    s_add_u32 s84, s69, 327680
    buffer_load_dwordx4 a[160:163], v6, s[44:47], s84 offen offset:0 sc1
    v_pk_mul_f32 v[188:189], v[188:189], v[208:209]
    v_pk_mul_f32 v[190:191], v[190:191], v[210:211]
    v_cvt_pk_bf16_f32 v192, v184, v185
    v_cvt_pk_bf16_f32 v193, v186, v187
    v_cvt_pk_bf16_f32 v194, v188, v189
    v_cvt_pk_bf16_f32 v195, v190, v191
    buffer_store_dwordx4 v[192:195], v6, s[44:47], s80 offen offset:1024 sc1
    v_pk_fma_f32 v[184:185], v[204:205], v[204:205], v[22:23] op_sel_hi:[1,1,0]
    v_pk_fma_f32 v[186:187], v[206:207], v[206:207], v[22:23] op_sel_hi:[1,1,0]
    v_pk_fma_f32 v[188:189], v[212:213], v[212:213], v[22:23] op_sel_hi:[1,1,0]
    v_pk_fma_f32 v[190:191], v[214:215], v[214:215], v[22:23] op_sel_hi:[1,1,0]
    v_pk_mul_f32 v[184:185], v[184:185], v[204:205] neg_lo:[0,1] neg_hi:[0,1]
    v_pk_mul_f32 v[186:187], v[186:187], v[206:207] neg_lo:[0,1] neg_hi:[0,1]
    v_pk_mul_f32 v[188:189], v[188:189], v[212:213] neg_lo:[0,1] neg_hi:[0,1]
    v_pk_mul_f32 v[190:191], v[190:191], v[214:215] neg_lo:[0,1] neg_hi:[0,1]
    v_exp_f32 v184, v184
    v_exp_f32 v185, v185
    v_exp_f32 v186, v186
    v_exp_f32 v187, v187
    v_exp_f32 v188, v188
    v_exp_f32 v189, v189
    v_exp_f32 v190, v190
    v_exp_f32 v191, v191
    s_waitcnt vmcnt(12)
    s_barrier
    ds_read_b128 v[232:235], v6 offset:20480
    ds_read_b128 v[236:239], v6 offset:21504
    ds_read_b128 v[240:243], v6 offset:22528
    buffer_load_dwordx4 a[164:167], v6, s[44:47], s84 offen offset:1024 sc1
    v_pk_add_f32 v[184:185], v[184:185], 1.0 op_sel_hi:[1,0]
    v_pk_add_f32 v[186:187], v[186:187], 1.0 op_sel_hi:[1,0]
    v_pk_add_f32 v[188:189], v[188:189], 1.0 op_sel_hi:[1,0]
    v_pk_add_f32 v[190:191], v[190:191], 1.0 op_sel_hi:[1,0]
    v_rcp_f32 v184, v184
    v_rcp_f32 v185, v185
    v_rcp_f32 v186, v186
    v_rcp_f32 v187, v187
    v_rcp_f32 v188, v188
    v_rcp_f32 v189, v189
    v_rcp_f32 v190, v190
    v_rcp_f32 v191, v191
    v_pk_mul_f32 v[184:185], v[184:185], v[204:205]
    v_pk_mul_f32 v[186:187], v[186:187], v[206:207]
    v_pk_mul_f32 v[188:189], v[188:189], v[212:213]
    v_pk_mul_f32 v[190:191], v[190:191], v[214:215]
    v_cvt_pk_bf16_f32 v196, v184, v185
    v_cvt_pk_bf16_f32 v197, v186, v187
    v_cvt_pk_bf16_f32 v198, v188, v189
    v_cvt_pk_bf16_f32 v199, v190, v191
    buffer_store_dwordx4 v[196:199], v6, s[44:47], s81 offen offset:1024 sc1
    s_waitcnt lgkmcnt(2)
    v_mfma_f32_16x16x32_bf16 v[216:219], v[232:235], v[24:27], v[216:219]
    ds_read_b128 v[244:247], v6 offset:23552
    v_mfma_f32_16x16x32_bf16 v[220:223], v[232:235], v[28:31], v[220:223]
    buffer_load_dwordx4 a[168:171], v6, s[44:47], s84 offen offset:2048 sc1
    s_waitcnt lgkmcnt(2)
    v_mfma_f32_16x16x32_bf16 v[224:227], v[236:239], v[24:27], v[224:227]
    ds_read_b128 v[232:235], v6 offset:24576
    v_mfma_f32_16x16x32_bf16 v[228:231], v[236:239], v[28:31], v[228:231]
    s_waitcnt lgkmcnt(2)
    v_mfma_f32_16x16x32_bf16 v[216:219], v[240:243], v[32:35], v[216:219]
    ds_read_b128 v[236:239], v6 offset:25600
    v_mfma_f32_16x16x32_bf16 v[220:223], v[240:243], v[36:39], v[220:223]
    s_waitcnt lgkmcnt(2)
    v_mfma_f32_16x16x32_bf16 v[224:227], v[244:247], v[32:35], v[224:227]
    ds_read_b128 v[240:243], v6 offset:26624
    v_mfma_f32_16x16x32_bf16 v[228:231], v[244:247], v[36:39], v[228:231]
    buffer_load_dwordx4 a[172:175], v6, s[44:47], s84 offen offset:3072 sc1
    s_waitcnt lgkmcnt(2)
    v_mfma_f32_16x16x32_bf16 v[216:219], v[232:235], v[40:43], v[216:219]
    ds_read_b128 v[244:247], v6 offset:27648
    v_mfma_f32_16x16x32_bf16 v[220:223], v[232:235], v[44:47], v[220:223]
    s_waitcnt lgkmcnt(2)
    v_mfma_f32_16x16x32_bf16 v[224:227], v[236:239], v[40:43], v[224:227]
    ds_read_b128 v[232:235], v6 offset:28672
    v_mfma_f32_16x16x32_bf16 v[228:231], v[236:239], v[44:47], v[228:231]
    s_waitcnt lgkmcnt(2)
    v_mfma_f32_16x16x32_bf16 v[216:219], v[240:243], v[48:51], v[216:219]
    ds_read_b128 v[236:239], v6 offset:29696
    v_mfma_f32_16x16x32_bf16 v[220:223], v[240:243], v[52:55], v[220:223]
    s_waitcnt lgkmcnt(2)
    v_mfma_f32_16x16x32_bf16 v[224:227], v[244:247], v[48:51], v[224:227]
    ds_read_b128 v[240:243], v6 offset:51200
    v_mfma_f32_16x16x32_bf16 v[228:231], v[244:247], v[52:55], v[228:231]
    s_add_u32 s84, s69, 331776
    buffer_load_dwordx4 a[176:179], v6, s[44:47], s84 offen offset:0 sc1
    s_waitcnt lgkmcnt(2)
    v_mfma_f32_16x16x32_bf16 v[216:219], v[232:235], v[56:59], v[216:219]
    ds_read_b128 v[244:247], v6 offset:52224
    v_mfma_f32_16x16x32_bf16 v[220:223], v[232:235], v[60:63], v[220:223]
    s_waitcnt lgkmcnt(2)
    v_mfma_f32_16x16x32_bf16 v[224:227], v[236:239], v[56:59], v[224:227]
    ds_read_b128 v[232:235], v6 offset:53248
    v_mfma_f32_16x16x32_bf16 v[228:231], v[236:239], v[60:63], v[228:231]
    s_waitcnt lgkmcnt(2)
    v_mfma_f32_16x16x32_bf16 v[216:219], v[240:243], v[64:67], v[216:219]
    ds_read_b128 v[236:239], v6 offset:54272
    v_mfma_f32_16x16x32_bf16 v[220:223], v[240:243], v[68:71], v[220:223]
    s_add_u32 s84, s69, 450560
    buffer_load_dwordx4 a[220:223], v6, s[44:47], s84 offen offset:0 sc1
    s_waitcnt lgkmcnt(2)
    v_mfma_f32_16x16x32_bf16 v[224:227], v[244:247], v[64:67], v[224:227]
    ds_read_b128 v[240:243], v6 offset:55296
    v_mfma_f32_16x16x32_bf16 v[228:231], v[244:247], v[68:71], v[228:231]
    s_waitcnt lgkmcnt(2)
    v_mfma_f32_16x16x32_bf16 v[216:219], v[232:235], v[72:75], v[216:219]
    ds_read_b128 v[244:247], v6 offset:56320
    v_mfma_f32_16x16x32_bf16 v[220:223], v[232:235], v[76:79], v[220:223]
    s_waitcnt lgkmcnt(2)
    v_mfma_f32_16x16x32_bf16 v[224:227], v[236:239], v[72:75], v[224:227]
    ds_read_b128 v[232:235], v6 offset:57344
    v_mfma_f32_16x16x32_bf16 v[228:231], v[236:239], v[76:79], v[228:231]
    s_waitcnt lgkmcnt(2)
    v_mfma_f32_16x16x32_bf16 v[216:219], v[240:243], v[80:83], v[216:219]
    ds_read_b128 v[236:239], v6 offset:58368
    v_mfma_f32_16x16x32_bf16 v[220:223], v[240:243], v[84:87], v[220:223]
    buffer_load_dwordx4 a[224:227], v6, s[44:47], s84 offen offset:1024 sc1
    s_waitcnt lgkmcnt(2)
    v_mfma_f32_16x16x32_bf16 v[224:227], v[244:247], v[80:83], v[224:227]
    ds_read_b128 v[240:243], v6 offset:59392
    v_mfma_f32_16x16x32_bf16 v[228:231], v[244:247], v[84:87], v[228:231]
    s_waitcnt lgkmcnt(2)
    v_mfma_f32_16x16x32_bf16 v[216:219], v[232:235], v[88:91], v[216:219]
    ds_read_b128 v[244:247], v6 offset:60416
    v_mfma_f32_16x16x32_bf16 v[220:223], v[232:235], v[92:95], v[220:223]
    s_waitcnt lgkmcnt(2)
    v_mfma_f32_16x16x32_bf16 v[224:227], v[236:239], v[88:91], v[224:227]
    ds_read_b128 v[232:235], v254 offset:20480
    v_mfma_f32_16x16x32_bf16 v[228:231], v[236:239], v[92:95], v[228:231]
    buffer_load_dwordx4 a[228:231], v6, s[44:47], s84 offen offset:2048 sc1
    s_waitcnt lgkmcnt(2)
    v_mfma_f32_16x16x32_bf16 v[216:219], v[240:243], v[96:99], v[216:219]
    ds_read_b128 v[236:239], v254 offset:21504
    v_mfma_f32_16x16x32_bf16 v[220:223], v[240:243], v[100:103], v[220:223]
    s_waitcnt lgkmcnt(2)
    v_mfma_f32_16x16x32_bf16 v[224:227], v[244:247], v[96:99], v[224:227]
    ds_read_b128 v[240:243], v254 offset:22528
    v_mfma_f32_16x16x32_bf16 v[228:231], v[244:247], v[100:103], v[228:231]
    s_cmp_eq_u32 s95, 0
    s_waitcnt vmcnt(6)
    s_cbranch_scc1 L_slow_pub1
    buffer_store_dword v253, v252, s[44:47], s92 offen offset:256
L_join_pub1:
    s_waitcnt lgkmcnt(2)
    v_mfma_f32_16x16x32_bf16 v[216:219], v[232:235], v[104:107], v[216:219]
    ds_read_b128 v[244:247], v254 offset:23552
    v_mfma_f32_16x16x32_bf16 v[220:223], v[232:235], v[108:111], v[220:223]
    s_waitcnt lgkmcnt(2)
    v_mfma_f32_16x16x32_bf16 v[224:227], v[236:239], v[104:107], v[224:227]
    ds_read_b128 v[232:235], v254 offset:24576
    v_mfma_f32_16x16x32_bf16 v[228:231], v[236:239], v[108:111], v[228:231]
    buffer_load_dwordx4 a[232:235], v6, s[44:47], s84 offen offset:3072 sc1
    s_waitcnt lgkmcnt(2)
    v_mfma_f32_16x16x32_bf16 v[216:219], v[240:243], v[112:115], v[216:219]
    ds_read_b128 v[236:239], v254 offset:25600
    v_mfma_f32_16x16x32_bf16 v[220:223], v[240:243], v[116:119], v[220:223]
    s_waitcnt lgkmcnt(2)
    v_mfma_f32_16x16x32_bf16 v[224:227], v[244:247], v[112:115], v[224:227]
    ds_read_b128 v[240:243], v254 offset:26624
    v_mfma_f32_16x16x32_bf16 v[228:231], v[244:247], v[116:119], v[228:231]
    s_waitcnt lgkmcnt(2)
    v_mfma_f32_16x16x32_bf16 v[216:219], v[232:235], v[120:123], v[216:219]
    ds_read_b128 v[244:247], v254 offset:27648
    v_mfma_f32_16x16x32_bf16 v[220:223], v[232:235], v[124:127], v[220:223]
    s_add_u32 s84, s69, 454656
    buffer_load_dwordx4 a[236:239], v6, s[44:47], s84 offen offset:0 sc1
    s_waitcnt lgkmcnt(2)
    v_mfma_f32_16x16x32_bf16 v[224:227], v[236:239], v[120:123], v[224:227]
    ds_read_b128 v[232:235], v254 offset:28672
    v_mfma_f32_16x16x32_bf16 v[228:231], v[236:239], v[124:127], v[228:231]
    s_waitcnt lgkmcnt(2)
    v_mfma_f32_16x16x32_bf16 v[216:219], v[240:243], v[128:131], v[216:219]
    ds_read_b128 v[236:239], v254 offset:29696
    v_mfma_f32_16x16x32_bf16 v[220:223], v[240:243], v[132:135], v[220:223]
    s_waitcnt lgkmcnt(2)
    v_mfma_f32_16x16x32_bf16 v[224:227], v[244:247], v[128:131], v[224:227]
    ds_read_b128 v[240:243], v254 offset:51200
    v_mfma_f32_16x16x32_bf16 v[228:231], v[244:247], v[132:135], v[228:231]
    s_waitcnt lgkmcnt(2)
    v_mfma_f32_16x16x32_bf16 v[216:219], v[232:235], v[136:139], v[216:219]
    ds_read_b128 v[244:247], v254 offset:52224
    v_mfma_f32_16x16x32_bf16 v[220:223], v[232:235], v[140:143], v[220:223]
    buffer_load_dwordx4 v[104:107], v248, s[40:43], 0 offen sc1
    s_waitcnt lgkmcnt(2)
    v_mfma_f32_16x16x32_bf16 v[224:227], v[236:239], v[136:139], v[224:227]
    ds_read_b128 v[232:235], v254 offset:53248
    v_mfma_f32_16x16x32_bf16 v[228:231], v[236:239], v[140:143], v[228:231]
    s_waitcnt lgkmcnt(2)
    v_mfma_f32_16x16x32_bf16 v[216:219], v[240:243], v[144:147], v[216:219]
    ds_read_b128 v[236:239], v254 offset:54272
    v_mfma_f32_16x16x32_bf16 v[220:223], v[240:243], v[148:151], v[220:223]
    s_waitcnt lgkmcnt(2)
    v_mfma_f32_16x16x32_bf16 v[224:227], v[244:247], v[144:147], v[224:227]
    ds_read_b128 v[240:243], v254 offset:55296
    v_mfma_f32_16x16x32_bf16 v[228:231], v[244:247], v[148:151], v[228:231]
    buffer_load_dwordx4 v[108:111], v248, s[40:43], 0 offen offset:64 sc1
    s_waitcnt lgkmcnt(2)
    v_mfma_f32_16x16x32_bf16 v[216:219], v[232:235], v[152:155], v[216:219]
    ds_read_b128 v[244:247], v254 offset:56320
    v_mfma_f32_16x16x32_bf16 v[220:223], v[232:235], v[156:159], v[220:223]
    buffer_load_dword v251, v250, s[44:47], s92 offen offset:256 sc1
    s_waitcnt lgkmcnt(2)
    v_mfma_f32_16x16x32_bf16 v[224:227], v[236:239], v[152:155], v[224:227]
    ds_read_b128 v[232:235], v254 offset:57344
    v_mfma_f32_16x16x32_bf16 v[228:231], v[236:239], v[156:159], v[228:231]
    s_waitcnt lgkmcnt(2)
    v_mfma_f32_16x16x32_bf16 v[216:219], v[240:243], v[160:163], v[216:219]
    ds_read_b128 v[236:239], v254 offset:58368
    v_mfma_f32_16x16x32_bf16 v[220:223], v[240:243], v[164:167], v[220:223]
    buffer_load_dwordx2 v[112:113], v249, s[40:43], 0 offen offset:128 sc1
    s_waitcnt lgkmcnt(2)
    v_mfma_f32_16x16x32_bf16 v[224:227], v[244:247], v[160:163], v[224:227]
    ds_read_b128 v[240:243], v254 offset:59392
    v_mfma_f32_16x16x32_bf16 v[228:231], v[244:247], v[164:167], v[228:231]
    s_waitcnt lgkmcnt(2)
    v_mfma_f32_16x16x32_bf16 v[216:219], v[232:235], v[168:171], v[216:219]
    ds_read_b128 v[244:247], v254 offset:60416
    v_mfma_f32_16x16x32_bf16 v[220:223], v[232:235], v[172:175], v[220:223]
    s_waitcnt lgkmcnt(2)
    v_mfma_f32_16x16x32_bf16 v[224:227], v[236:239], v[168:171], v[224:227]
    v_mfma_f32_16x16x32_bf16 v[228:231], v[236:239], v[172:175], v[228:231]
    s_waitcnt lgkmcnt(1)
    v_mfma_f32_16x16x32_bf16 v[216:219], v[240:243], v[176:179], v[216:219]
    v_mfma_f32_16x16x32_bf16 v[220:223], v[240:243], v[180:183], v[220:223]
    s_waitcnt lgkmcnt(0)
    v_mfma_f32_16x16x32_bf16 v[224:227], v[244:247], v[176:179], v[224:227]
    v_mfma_f32_16x16x32_bf16 v[228:231], v[244:247], v[180:183], v[228:231]
    s_barrier
    s_nop 2
    v_pk_fma_f32 v[184:185], v[216:217], v[216:217], v[22:23] op_sel_hi:[1,1,0]
    v_pk_fma_f32 v[186:187], v[218:219], v[218:219], v[22:23] op_sel_hi:[1,1,0]
    s_nop 0
    v_pk_fma_f32 v[188:189], v[224:225], v[224:225], v[22:23] op_sel_hi:[1,1,0]
    v_pk_fma_f32 v[190:191], v[226:227], v[226:227], v[22:23] op_sel_hi:[1,1,0]
    v_pk_mul_f32 v[184:185], v[184:185], v[216:217] neg_lo:[0,1] neg_hi:[0,1]
    v_pk_mul_f32 v[186:187], v[186:187], v[218:219] neg_lo:[0,1] neg_hi:[0,1]
    v_pk_mul_f32 v[188:189], v[188:189], v[224:225] neg_lo:[0,1] neg_hi:[0,1]
    v_pk_mul_f32 v[190:191], v[190:191], v[226:227] neg_lo:[0,1] neg_hi:[0,1]
    v_exp_f32 v184, v184
    v_exp_f32 v185, v185
    v_exp_f32 v186, v186
    v_exp_f32 v187, v187
    v_exp_f32 v188, v188
    v_exp_f32 v189, v189
    v_exp_f32 v190, v190
    v_exp_f32 v191, v191
    v_pk_add_f32 v[184:185], v[184:185], 1.0 op_sel_hi:[1,0]
    v_pk_add_f32 v[186:187], v[186:187], 1.0 op_sel_hi:[1,0]
    v_pk_add_f32 v[188:189], v[188:189], 1.0 op_sel_hi:[1,0]
    v_pk_add_f32 v[190:191], v[190:191], 1.0 op_sel_hi:[1,0]
    v_rcp_f32 v184, v184
    v_rcp_f32 v185, v185
    v_rcp_f32 v186, v186
    v_rcp_f32 v187, v187
    v_rcp_f32 v188, v188
    v_rcp_f32 v189, v189
    v_rcp_f32 v190, v190
    v_rcp_f32 v191, v191
    v_pk_mul_f32 v[184:185], v[184:185], v[216:217]
    v_pk_mul_f32 v[186:187], v[186:187], v[218:219]
    v_pk_mul_f32 v[188:189], v[188:189], v[224:225]
    v_pk_mul_f32 v[190:191], v[190:191], v[226:227]
    v_cvt_pk_bf16_f32 v192, v184, v185
    v_cvt_pk_bf16_f32 v193, v186, v187
    v_cvt_pk_bf16_f32 v194, v188, v189
    v_cvt_pk_bf16_f32 v195, v190, v191
    buffer_store_dwordx4 v[192:195], v6, s[44:47], s80 offen offset:2048 sc1
L_chk_fl1:
    s_waitcnt vmcnt(2)
    v_cmp_ne_u32 vcc, s50, v251
    s_cbranch_vccnz L_retry_fl1
L_ok_fl1:
    buffer_load_dwordx4 v[24:27], v6, s[44:47], s72 offen offset:0 sc1
    v_pk_fma_f32 v[184:185], v[220:221], v[220:221], v[22:23] op_sel_hi:[1,1,0]
    v_pk_fma_f32 v[186:187], v[222:223], v[222:223], v[22:23] op_sel_hi:[1,1,0]
    v_pk_fma_f32 v[188:189], v[228:229], v[228:229], v[22:23] op_sel_hi:[1,1,0]
    v_pk_fma_f32 v[190:191], v[230:231], v[230:231], v[22:23] op_sel_hi:[1,1,0]
    v_pk_mul_f32 v[184:185], v[184:185], v[220:221] neg_lo:[0,1] neg_hi:[0,1]
    buffer_load_dwordx4 v[28:31], v6, s[44:47], s72 offen offset:1024 sc1
    v_pk_mul_f32 v[186:187], v[186:187], v[222:223] neg_lo:[0,1] neg_hi:[0,1]
    v_pk_mul_f32 v[188:189], v[188:189], v[228:229] neg_lo:[0,1] neg_hi:[0,1]
    v_pk_mul_f32 v[190:191], v[190:191], v[230:231] neg_lo:[0,1] neg_hi:[0,1]
    v_exp_f32 v184, v184
    buffer_load_dwordx4 v[32:35], v6, s[44:47], s72 offen offset:3072 sc1
    v_exp_f32 v185, v185
    v_exp_f32 v186, v186
    buffer_load_dwordx4 v[36:39], v18, s[44:47], s72 offen offset:0 sc1
    v_exp_f32 v187, v187
    v_exp_f32 v188, v188
    v_exp_f32 v189, v189
    buffer_load_dwordx4 v[40:43], v18, s[44:47], s72 offen offset:2048 sc1
    v_exp_f32 v190, v190
    v_exp_f32 v191, v191
    buffer_load_dwordx4 v[44:47], v18, s[44:47], s72 offen offset:3072 sc1
    v_pk_add_f32 v[184:185], v[184:185], 1.0 op_sel_hi:[1,0]
    v_pk_add_f32 v[186:187], v[186:187], 1.0 op_sel_hi:[1,0]
    v_pk_add_f32 v[188:189], v[188:189], 1.0 op_sel_hi:[1,0]
    v_pk_add_f32 v[190:191], v[190:191], 1.0 op_sel_hi:[1,0]
    buffer_load_dwordx4 v[48:51], v19, s[44:47], s72 offen offset:1024 sc1
    v_rcp_f32 v184, v184
    v_rcp_f32 v185, v185
    v_rcp_f32 v186, v186
    buffer_load_dwordx4 v[52:55], v19, s[44:47], s72 offen offset:2048 sc1
    v_rcp_f32 v187, v187
    v_rcp_f32 v188, v188
    v_rcp_f32 v189, v189
    v_rcp_f32 v190, v190
    v_rcp_f32 v191, v191
    v_pk_mul_f32 v[184:185], v[184:185], v[220:221]
    v_pk_mul_f32 v[186:187], v[186:187], v[222:223]
    v_pk_mul_f32 v[188:189], v[188:189], v[228:229]
    v_pk_mul_f32 v[190:191], v[190:191], v[230:231]
    v_cvt_pk_bf16_f32 v196, v184, v185
    v_cvt_pk_bf16_f32 v197, v186, v187
    v_cvt_pk_bf16_f32 v198, v188, v189
    v_cvt_pk_bf16_f32 v199, v190, v191
    buffer_store_dwordx4 v[196:199], v6, s[44:47], s81 offen offset:2048 sc1
    s_waitcnt vmcnt(8)
    v_mfma_f32_16x16x32_bf16 v[120:123], a[0:3], v[24:27], 0
    buffer_load_dwordx4 v[56:59], v6, s[44:47], s73 offen offset:0 sc1
    v_mfma_f32_16x16x32_bf16 v[124:127], a[4:7], v[24:27], 0
    v_mfma_f32_16x16x32_bf16 v[128:131], a[8:11], v[24:27], 0
    v_mfma_f32_16x16x32_bf16 v[132:135], a[12:15], v[24:27], 0
    v_mfma_f32_16x16x32_bf16 v[136:139], a[16:19], v[24:27], 0
    s_waitcnt vmcnt(8)
    v_mfma_f32_16x16x32_bf16 v[120:123], a[20:23], v[28:31], v[120:123]
    buffer_load_dwordx4 v[60:63], v6, s[44:47], s73 offen offset:1024 sc1
    v_mfma_f32_16x16x32_bf16 v[124:127], a[24:27], v[28:31], v[124:127]
    v_and_b32 v20, 3, v1
    v_mfma_f32_16x16x32_bf16 v[128:131], a[28:31], v[28:31], v[128:131]
    v_lshlrev_b32 v21, 4, v20
    v_mfma_f32_16x16x32_bf16 v[132:135], a[32:35], v[28:31], v[132:135]
    v_add_u32 v21, 142976, v21
    v_mfma_f32_16x16x32_bf16 v[136:139], a[36:39], v[28:31], v[136:139]
    v_lshl_add_u32 v20, v20, 4, v21
    s_waitcnt vmcnt(8)
    v_mfma_f32_16x16x32_bf16 v[120:123], a[60:63], v[32:35], v[120:123]
    buffer_load_dwordx4 v[64:67], v6, s[44:47], s73 offen offset:3072 sc1
    v_mfma_f32_16x16x32_bf16 v[124:127], a[64:67], v[32:35], v[124:127]
    ds_read_b128 v[200:203], v20 offset:528
    v_mfma_f32_16x16x32_bf16 v[128:131], a[68:71], v[32:35], v[128:131]
    ds_read_b128 v[204:207], v20 offset:544
    v_mfma_f32_16x16x32_bf16 v[132:135], a[72:75], v[32:35], v[132:135]
    ds_read_b128 v[208:211], v20 offset:656
    v_mfma_f32_16x16x32_bf16 v[136:139], a[76:79], v[32:35], v[136:139]
    ds_read_b128 v[212:215], v20 offset:672
    s_waitcnt vmcnt(8)
    v_mfma_f32_16x16x32_bf16 v[120:123], a[80:83], v[36:39], v[120:123]
    buffer_load_dwordx4 v[68:71], v18, s[44:47], s73 offen offset:0 sc1
    v_mfma_f32_16x16x32_bf16 v[124:127], a[84:87], v[36:39], v[124:127]
    ds_read_b128 v[216:219], v21 offset:784
    v_mfma_f32_16x16x32_bf16 v[128:131], a[88:91], v[36:39], v[128:131]
    ds_read_b128 v[220:223], v20 offset:0
    v_mfma_f32_16x16x32_bf16 v[132:135], a[92:95], v[36:39], v[132:135]
    ds_read_b128 v[224:227], v20 offset:16
    v_mfma_f32_16x16x32_bf16 v[136:139], a[96:99], v[36:39], v[136:139]
    ds_read_b128 v[228:231], v20 offset:128
    s_waitcnt vmcnt(8)
    v_mfma_f32_16x16x32_bf16 v[120:123], a[120:123], v[40:43], v[120:123]
    buffer_load_dwordx4 v[72:75], v18, s[44:47], s73 offen offset:2048 sc1
    v_mfma_f32_16x16x32_bf16 v[124:127], a[124:127], v[40:43], v[124:127]
    ds_read_b128 v[232:235], v20 offset:144
    v_mfma_f32_16x16x32_bf16 v[128:131], a[128:131], v[40:43], v[128:131]
    ds_read_b128 v[236:239], v21 offset:256
    v_mfma_f32_16x16x32_bf16 v[132:135], a[132:135], v[40:43], v[132:135]
    v_lshlrev_b32 v114, 16, v104
    v_mfma_f32_16x16x32_bf16 v[136:139], a[136:139], v[40:43], v[136:139]
    v_and_b32 v115, s3, v104
    s_waitcnt vmcnt(8)
    v_mfma_f32_16x16x32_bf16 v[120:123], a[140:143], v[44:47], v[120:123]
    buffer_load_dwordx4 v[76:79], v18, s[44:47], s73 offen offset:3072 sc1
    v_mfma_f32_16x16x32_bf16 v[124:127], a[144:147], v[44:47], v[124:127]
    s_waitcnt lgkmcnt(9)
    v_add_f32 v200, v114, v200
    v_mfma_f32_16x16x32_bf16 v[128:131], a[148:151], v[44:47], v[128:131]
    v_add_f32 v201, v115, v201
    v_mfma_f32_16x16x32_bf16 v[132:135], a[152:155], v[44:47], v[132:135]
    v_lshlrev_b32 v114, 16, v105
    v_mfma_f32_16x16x32_bf16 v[136:139], a[156:159], v[44:47], v[136:139]
    v_and_b32 v115, s3, v105
    s_waitcnt vmcnt(8)
    v_mfma_f32_16x16x32_bf16 v[120:123], a[180:183], v[48:51], v[120:123]
    s_cmp_eq_u32 s95, 0
    s_waitcnt vmcnt(6)
    s_cbranch_scc1 L_slow_pub2
    buffer_store_dword v253, v252, s[44:47], s92 offen offset:512
L_join_pub2:
    buffer_load_dwordx4 v[80:83], v19, s[44:47], s73 offen offset:1024 sc1
    v_mfma_f32_16x16x32_bf16 v[124:127], a[184:187], v[48:51], v[124:127]
    v_add_f32 v202, v114, v202
    v_mfma_f32_16x16x32_bf16 v[128:131], a[188:191], v[48:51], v[128:131]
    v_add_f32 v203, v115, v203
    v_mfma_f32_16x16x32_bf16 v[132:135], a[192:195], v[48:51], v[132:135]
    v_lshlrev_b32 v114, 16, v106
    v_mfma_f32_16x16x32_bf16 v[136:139], a[196:199], v[48:51], v[136:139]
    v_and_b32 v115, s3, v106
    v_mfma_f32_16x16x32_bf16 v[120:123], a[200:203], v[52:55], v[120:123]
    buffer_load_dwordx4 v[84:87], v19, s[44:47], s73 offen offset:2048 sc1
    v_mfma_f32_16x16x32_bf16 v[124:127], a[204:207], v[52:55], v[124:127]
    s_waitcnt lgkmcnt(8)
    v_add_f32 v204, v114, v204
    v_mfma_f32_16x16x32_bf16 v[128:131], a[208:211], v[52:55], v[128:131]
    v_add_f32 v205, v115, v205
    v_mfma_f32_16x16x32_bf16 v[132:135], a[212:215], v[52:55], v[132:135]
    v_lshlrev_b32 v114, 16, v107
    v_mfma_f32_16x16x32_bf16 v[136:139], a[216:219], v[52:55], v[136:139]
    v_and_b32 v115, s3, v107
    s_waitcnt vmcnt(8)
    v_mfma_f32_16x16x32_bf16 v[140:143], a[0:3], v[56:59], 0
    buffer_load_dwordx4 v[88:91], v6, s[44:47], s74 offen offset:0 sc1
    v_mfma_f32_16x16x32_bf16 v[144:147], a[4:7], v[56:59], 0
    v_add_f32 v206, v114, v206
    v_mfma_f32_16x16x32_bf16 v[148:151], a[8:11], v[56:59], 0
    v_add_f32 v207, v115, v207
    v_mfma_f32_16x16x32_bf16 v[152:155], a[12:15], v[56:59], 0
    v_lshlrev_b32 v114, 16, v108
    v_mfma_f32_16x16x32_bf16 v[156:159], a[16:19], v[56:59], 0
    v_and_b32 v115, s3, v108
    s_waitcnt vmcnt(8)
    v_mfma_f32_16x16x32_bf16 v[140:143], a[20:23], v[60:63], v[140:143]
    buffer_load_dwordx4 v[92:95], v6, s[44:47], s74 offen offset:1024 sc1
    v_mfma_f32_16x16x32_bf16 v[144:147], a[24:27], v[60:63], v[144:147]
    s_waitcnt lgkmcnt(7)
    v_add_f32 v208, v114, v208
    v_mfma_f32_16x16x32_bf16 v[148:151], a[28:31], v[60:63], v[148:151]
    v_add_f32 v209, v115, v209
    v_mfma_f32_16x16x32_bf16 v[152:155], a[32:35], v[60:63], v[152:155]
    v_lshlrev_b32 v114, 16, v109
    v_mfma_f32_16x16x32_bf16 v[156:159], a[36:39], v[60:63], v[156:159]
    v_and_b32 v115, s3, v109
    s_waitcnt vmcnt(8)
    v_mfma_f32_16x16x32_bf16 v[140:143], a[60:63], v[64:67], v[140:143]
    buffer_load_dwordx4 v[96:99], v6, s[44:47], s74 offen offset:3072 sc1
    v_mfma_f32_16x16x32_bf16 v[144:147], a[64:67], v[64:67], v[144:147]
    v_add_f32 v210, v114, v210
    v_mfma_f32_16x16x32_bf16 v[148:151], a[68:71], v[64:67], v[148:151]
    v_add_f32 v211, v115, v211
    v_mfma_f32_16x16x32_bf16 v[152:155], a[72:75], v[64:67], v[152:155]
    v_lshlrev_b32 v114, 16, v110
    v_mfma_f32_16x16x32_bf16 v[156:159], a[76:79], v[64:67], v[156:159]
    v_and_b32 v115, s3, v110
    s_waitcnt vmcnt(8)
    v_mfma_f32_16x16x32_bf16 v[140:143], a[80:83], v[68:71], v[140:143]
    buffer_load_dwordx4 v[100:103], v18, s[44:47], s74 offen offset:0 sc1
    v_mfma_f32_16x16x32_bf16 v[144:147], a[84:87], v[68:71], v[144:147]
    s_waitcnt lgkmcnt(6)
    v_add_f32 v212, v114, v212
    v_mfma_f32_16x16x32_bf16 v[148:151], a[88:91], v[68:71], v[148:151]
    v_add_f32 v213, v115, v213
    v_mfma_f32_16x16x32_bf16 v[152:155], a[92:95], v[68:71], v[152:155]
    v_lshlrev_b32 v114, 16, v111
    v_mfma_f32_16x16x32_bf16 v[156:159], a[96:99], v[68:71], v[156:159]
    v_and_b32 v115, s3, v111
    s_waitcnt vmcnt(8)
    v_mfma_f32_16x16x32_bf16 v[140:143], a[120:123], v[72:75], v[140:143]
    buffer_load_dwordx4 v[24:27], v18, s[44:47], s74 offen offset:2048 sc1
    v_mfma_f32_16x16x32_bf16 v[144:147], a[124:127], v[72:75], v[144:147]
    v_add_f32 v214, v114, v214
    v_mfma_f32_16x16x32_bf16 v[148:151], a[128:131], v[72:75], v[148:151]
    v_add_f32 v215, v115, v215
    buffer_load_dword v251, v250, s[44:47], s92 offen offset:512 sc1
    v_mfma_f32_16x16x32_bf16 v[152:155], a[132:135], v[72:75], v[152:155]
    v_lshlrev_b32 v114, 16, v112
    v_mfma_f32_16x16x32_bf16 v[156:159], a[136:139], v[72:75], v[156:159]
    v_and_b32 v115, s3, v112
    s_waitcnt vmcnt(9)
    v_mfma_f32_16x16x32_bf16 v[140:143], a[140:143], v[76:79], v[140:143]
    buffer_load_dwordx4 v[28:31], v18, s[44:47], s74 offen offset:3072 sc1
    v_mfma_f32_16x16x32_bf16 v[144:147], a[144:147], v[76:79], v[144:147]
    s_waitcnt lgkmcnt(5)
    v_add_f32 v216, v114, v216
    v_mfma_f32_16x16x32_bf16 v[148:151], a[148:151], v[76:79], v[148:151]
    v_add_f32 v217, v115, v217
    v_mfma_f32_16x16x32_bf16 v[152:155], a[152:155], v[76:79], v[152:155]
    v_lshlrev_b32 v114, 16, v113
    v_mfma_f32_16x16x32_bf16 v[156:159], a[156:159], v[76:79], v[156:159]
    v_and_b32 v115, s3, v113
    s_waitcnt vmcnt(8)
    v_mfma_f32_16x16x32_bf16 v[140:143], a[180:183], v[80:83], v[140:143]
    buffer_load_dwordx4 v[32:35], v19, s[44:47], s74 offen offset:1024 sc1
    v_mfma_f32_16x16x32_bf16 v[144:147], a[184:187], v[80:83], v[144:147]
    v_add_f32 v218, v114, v218
    v_mfma_f32_16x16x32_bf16 v[148:151], a[188:191], v[80:83], v[148:151]
    v_add_f32 v219, v115, v219
    v_mfma_f32_16x16x32_bf16 v[152:155], a[192:195], v[80:83], v[152:155]
    v_mfma_f32_16x16x32_bf16 v[156:159], a[196:199], v[80:83], v[156:159]
    s_waitcnt vmcnt(8)
    v_mfma_f32_16x16x32_bf16 v[140:143], a[200:203], v[84:87], v[140:143]
    buffer_load_dwordx4 v[36:39], v19, s[44:47], s74 offen offset:2048 sc1
    v_mfma_f32_16x16x32_bf16 v[144:147], a[204:207], v[84:87], v[144:147]
    v_mfma_f32_16x16x32_bf16 v[148:151], a[208:211], v[84:87], v[148:151]
    v_mfma_f32_16x16x32_bf16 v[152:155], a[212:215], v[84:87], v[152:155]
    v_mfma_f32_16x16x32_bf16 v[156:159], a[216:219], v[84:87], v[156:159]
    s_waitcnt vmcnt(8)
    v_mfma_f32_16x16x32_bf16 v[160:163], a[0:3], v[88:91], 0
    buffer_load_dwordx4 v[40:43], v6, s[44:47], s75 offen offset:0 sc1
    v_mfma_f32_16x16x32_bf16 v[164:167], a[4:7], v[88:91], 0
    v_mfma_f32_16x16x32_bf16 v[168:171], a[8:11], v[88:91], 0
    v_mfma_f32_16x16x32_bf16 v[172:175], a[12:15], v[88:91], 0
    v_mfma_f32_16x16x32_bf16 v[176:179], a[16:19], v[88:91], 0
    s_waitcnt vmcnt(8)
    v_mfma_f32_16x16x32_bf16 v[160:163], a[20:23], v[92:95], v[160:163]
    buffer_load_dwordx4 v[44:47], v6, s[44:47], s75 offen offset:1024 sc1
    v_mfma_f32_16x16x32_bf16 v[164:167], a[24:27], v[92:95], v[164:167]
    v_mfma_f32_16x16x32_bf16 v[168:171], a[28:31], v[92:95], v[168:171]
    v_mfma_f32_16x16x32_bf16 v[172:175], a[32:35], v[92:95], v[172:175]
    v_mfma_f32_16x16x32_bf16 v[176:179], a[36:39], v[92:95], v[176:179]
    s_waitcnt vmcnt(8)
    v_mfma_f32_16x16x32_bf16 v[160:163], a[60:63], v[96:99], v[160:163]
    buffer_load_dwordx4 v[48:51], v6, s[44:47], s75 offen offset:3072 sc1
    v_mfma_f32_16x16x32_bf16 v[164:167], a[64:67], v[96:99], v[164:167]
    v_mfma_f32_16x16x32_bf16 v[168:171], a[68:71], v[96:99], v[168:171]
    v_mfma_f32_16x16x32_bf16 v[172:175], a[72:75], v[96:99], v[172:175]
    v_mfma_f32_16x16x32_bf16 v[176:179], a[76:79], v[96:99], v[176:179]
    s_waitcnt vmcnt(8)
    v_mfma_f32_16x16x32_bf16 v[160:163], a[80:83], v[100:103], v[160:163]
    v_mfma_f32_16x16x32_bf16 v[164:167], a[84:87], v[100:103], v[164:167]
L_chk_fl2:
    s_waitcnt vmcnt(6)
    v_cmp_ne_u32 vcc, s50, v251
    s_cbranch_vccnz L_retry_fl2
L_ok_fl2:
    v_mfma_f32_16x16x32_bf16 v[168:171], a[88:91], v[100:103], v[168:171]
    v_mfma_f32_16x16x32_bf16 v[172:175], a[92:95], v[100:103], v[172:175]
    buffer_load_dwordx4 v[52:55], v6, s[44:47], s72 offen offset:2048 sc1
    v_mfma_f32_16x16x32_bf16 v[176:179], a[96:99], v[100:103], v[176:179]
    v_mfma_f32_16x16x32_bf16 v[160:163], a[120:123], v[24:27], v[160:163]
    buffer_load_dwordx4 v[56:59], v18, s[44:47], s72 offen offset:1024 sc1
    v_mfma_f32_16x16x32_bf16 v[164:167], a[124:127], v[24:27], v[164:167]
    v_mfma_f32_16x16x32_bf16 v[168:171], a[128:131], v[24:27], v[168:171]
    v_mfma_f32_16x16x32_bf16 v[172:175], a[132:135], v[24:27], v[172:175]
    v_mfma_f32_16x16x32_bf16 v[176:179], a[136:139], v[24:27], v[176:179]
    s_waitcnt vmcnt(7)
    v_mfma_f32_16x16x32_bf16 v[160:163], a[140:143], v[28:31], v[160:163]
    buffer_load_dwordx4 v[60:63], v19, s[44:47], s72 offen offset:0 sc1
    v_mfma_f32_16x16x32_bf16 v[164:167], a[144:147], v[28:31], v[164:167]
    v_mfma_f32_16x16x32_bf16 v[168:171], a[148:151], v[28:31], v[168:171]
    v_mfma_f32_16x16x32_bf16 v[172:175], a[152:155], v[28:31], v[172:175]
    v_mfma_f32_16x16x32_bf16 v[176:179], a[156:159], v[28:31], v[176:179]
    s_waitcnt vmcnt(7)
    v_mfma_f32_16x16x32_bf16 v[160:163], a[180:183], v[32:35], v[160:163]
    buffer_load_dwordx4 v[64:67], v19, s[44:47], s72 offen offset:3072 sc1
    v_mfma_f32_16x16x32_bf16 v[164:167], a[184:187], v[32:35], v[164:167]
    v_mfma_f32_16x16x32_bf16 v[168:171], a[188:191], v[32:35], v[168:171]
    v_mfma_f32_16x16x32_bf16 v[172:175], a[192:195], v[32:35], v[172:175]
    v_mfma_f32_16x16x32_bf16 v[176:179], a[196:199], v[32:35], v[176:179]
    s_waitcnt vmcnt(7)
    v_mfma_f32_16x16x32_bf16 v[160:163], a[200:203], v[36:39], v[160:163]
    buffer_load_dwordx4 v[68:71], v6, s[44:47], s73 offen offset:2048 sc1
    v_mfma_f32_16x16x32_bf16 v[164:167], a[204:207], v[36:39], v[164:167]
    v_mfma_f32_16x16x32_bf16 v[168:171], a[208:211], v[36:39], v[168:171]
    v_mfma_f32_16x16x32_bf16 v[172:175], a[212:215], v[36:39], v[172:175]
    v_mfma_f32_16x16x32_bf16 v[176:179], a[216:219], v[36:39], v[176:179]
    s_waitcnt vmcnt(7)
    v_mfma_f32_16x16x32_bf16 v[180:183], a[0:3], v[40:43], 0
    buffer_load_dwordx4 v[72:75], v18, s[44:47], s73 offen offset:1024 sc1
    v_mfma_f32_16x16x32_bf16 v[184:187], a[4:7], v[40:43], 0
    v_mfma_f32_16x16x32_bf16 v[188:191], a[8:11], v[40:43], 0
    v_mfma_f32_16x16x32_bf16 v[192:195], a[12:15], v[40:43], 0
    v_mfma_f32_16x16x32_bf16 v[196:199], a[16:19], v[40:43], 0
    s_waitcnt vmcnt(7)
    v_mfma_f32_16x16x32_bf16 v[180:183], a[20:23], v[44:47], v[180:183]
    buffer_load_dwordx4 v[76:79], v19, s[44:47], s73 offen offset:0 sc1
    v_mfma_f32_16x16x32_bf16 v[184:187], a[24:27], v[44:47], v[184:187]
    v_mfma_f32_16x16x32_bf16 v[188:191], a[28:31], v[44:47], v[188:191]
    v_mfma_f32_16x16x32_bf16 v[192:195], a[32:35], v[44:47], v[192:195]
    v_mfma_f32_16x16x32_bf16 v[196:199], a[36:39], v[44:47], v[196:199]
    s_waitcnt vmcnt(7)
    v_mfma_f32_16x16x32_bf16 v[180:183], a[60:63], v[48:51], v[180:183]
    buffer_load_dwordx4 v[80:83], v19, s[44:47], s73 offen offset:3072 sc1
    v_mfma_f32_16x16x32_bf16 v[184:187], a[64:67], v[48:51], v[184:187]
    v_mfma_f32_16x16x32_bf16 v[188:191], a[68:71], v[48:51], v[188:191]
    v_mfma_f32_16x16x32_bf16 v[192:195], a[72:75], v[48:51], v[192:195]
    v_mfma_f32_16x16x32_bf16 v[196:199], a[76:79], v[48:51], v[196:199]
    s_waitcnt vmcnt(7)
    v_mfma_f32_16x16x32_bf16 v[120:123], a[40:43], v[52:55], v[120:123]
    buffer_load_dwordx4 v[84:87], v6, s[44:47], s74 offen offset:2048 sc1
    v_mfma_f32_16x16x32_bf16 v[124:127], a[44:47], v[52:55], v[124:127]
    v_mfma_f32_16x16x32_bf16 v[128:131], a[48:51], v[52:55], v[128:131]
    v_mfma_f32_16x16x32_bf16 v[132:135], a[52:55], v[52:55], v[132:135]
    v_mfma_f32_16x16x32_bf16 v[136:139], a[56:59], v[52:55], v[136:139]
    s_waitcnt vmcnt(7)
    v_mfma_f32_16x16x32_bf16 v[120:123], a[100:103], v[56:59], v[120:123]
    buffer_load_dwordx4 v[88:91], v18, s[44:47], s74 offen offset:1024 sc1
    v_mfma_f32_16x16x32_bf16 v[124:127], a[104:107], v[56:59], v[124:127]
    v_mfma_f32_16x16x32_bf16 v[128:131], a[108:111], v[56:59], v[128:131]
    v_mfma_f32_16x16x32_bf16 v[132:135], a[112:115], v[56:59], v[132:135]
    v_mfma_f32_16x16x32_bf16 v[136:139], a[116:119], v[56:59], v[136:139]
    s_waitcnt vmcnt(7)
    v_mfma_f32_16x16x32_bf16 v[120:123], a[160:163], v[60:63], v[120:123]
    buffer_load_dwordx4 v[92:95], v19, s[44:47], s74 offen offset:0 sc1
    v_mfma_f32_16x16x32_bf16 v[124:127], a[164:167], v[60:63], v[124:127]
    v_mfma_f32_16x16x32_bf16 v[128:131], a[168:171], v[60:63], v[128:131]
    v_mfma_f32_16x16x32_bf16 v[132:135], a[172:175], v[60:63], v[132:135]
    v_mfma_f32_16x16x32_bf16 v[136:139], a[176:179], v[60:63], v[136:139]
    s_waitcnt vmcnt(7)
    v_mfma_f32_16x16x32_bf16 v[120:123], a[220:223], v[64:67], v[120:123]
    buffer_load_dwordx4 v[96:99], v19, s[44:47], s74 offen offset:3072 sc1
    v_mfma_f32_16x16x32_bf16 v[124:127], a[224:227], v[64:67], v[124:127]
    v_mfma_f32_16x16x32_bf16 v[128:131], a[228:231], v[64:67], v[128:131]
    v_mfma_f32_16x16x32_bf16 v[132:135], a[232:235], v[64:67], v[132:135]
    v_mfma_f32_16x16x32_bf16 v[136:139], a[236:239], v[64:67], v[136:139]
    s_waitcnt vmcnt(7)
    v_mfma_f32_16x16x32_bf16 v[140:143], a[40:43], v[68:71], v[140:143]
    buffer_load_dwordx4 v[100:103], v18, s[44:47], s75 offen offset:0 sc1
    v_mfma_f32_16x16x32_bf16 v[144:147], a[44:47], v[68:71], v[144:147]
    v_mfma_f32_16x16x32_bf16 v[148:151], a[48:51], v[68:71], v[148:151]
    v_mfma_f32_16x16x32_bf16 v[152:155], a[52:55], v[68:71], v[152:155]
    ds_write_b128 v12, v[120:123] offset:0
    v_mfma_f32_16x16x32_bf16 v[156:159], a[56:59], v[68:71], v[156:159]
    s_waitcnt vmcnt(7)
    v_mfma_f32_16x16x32_bf16 v[140:143], a[100:103], v[72:75], v[140:143]
    ds_write_b128 v12, v[124:127] offset:64
    buffer_load_dwordx4 v[24:27], v18, s[44:47], s75 offen offset:2048 sc1
    v_mfma_f32_16x16x32_bf16 v[144:147], a[104:107], v[72:75], v[144:147]
    v_mfma_f32_16x16x32_bf16 v[148:151], a[108:111], v[72:75], v[148:151]
    ds_write_b128 v12, v[128:131] offset:128
    v_mfma_f32_16x16x32_bf16 v[152:155], a[112:115], v[72:75], v[152:155]
    v_mfma_f32_16x16x32_bf16 v[156:159], a[116:119], v[72:75], v[156:159]
    ds_write_b128 v12, v[132:135] offset:192
    s_waitcnt vmcnt(7)
    v_mfma_f32_16x16x32_bf16 v[140:143], a[160:163], v[76:79], v[140:143]
    buffer_load_dwordx4 v[28:31], v18, s[44:47], s75 offen offset:3072 sc1
    v_mfma_f32_16x16x32_bf16 v[144:147], a[164:167], v[76:79], v[144:147]
    ds_write_b128 v12, v[136:139] offset:256
    v_mfma_f32_16x16x32_bf16 v[148:151], a[168:171], v[76:79], v[148:151]
    v_mfma_f32_16x16x32_bf16 v[152:155], a[172:175], v[76:79], v[152:155]
    v_mfma_f32_16x16x32_bf16 v[156:159], a[176:179], v[76:79], v[156:159]
    s_waitcnt vmcnt(7)
    v_mfma_f32_16x16x32_bf16 v[140:143], a[220:223], v[80:83], v[140:143]
    s_waitcnt lgkmcnt(0)
    s_barrier
    ds_read_b128 v[120:123], v16 offset:0
    buffer_load_dwordx4 v[32:35], v19, s[44:47], s75 offen offset:1024 sc1
    v_mfma_f32_16x16x32_bf16 v[144:147], a[224:227], v[80:83], v[144:147]
    ds_read_b128 v[124:127], v16 offset:16
    v_mfma_f32_16x16x32_bf16 v[148:151], a[228:231], v[80:83], v[148:151]
    ds_read_b128 v[128:131], v16 offset:128
    v_mfma_f32_16x16x32_bf16 v[152:155], a[232:235], v[80:83], v[152:155]
    ds_read_b128 v[132:135], v16 offset:144
    v_mfma_f32_16x16x32_bf16 v[156:159], a[236:239], v[80:83], v[156:159]
    ds_read_b128 v[136:139], v17 offset:256
    s_waitcnt vmcnt(7)
    v_mfma_f32_16x16x32_bf16 v[160:163], a[40:43], v[84:87], v[160:163]
    buffer_load_dwordx4 v[36:39], v19, s[44:47], s75 offen offset:2048 sc1
    v_mfma_f32_16x16x32_bf16 v[164:167], a[44:47], v[84:87], v[164:167]
    v_mfma_f32_16x16x32_bf16 v[168:171], a[48:51], v[84:87], v[168:171]
    s_waitcnt lgkmcnt(4)
    v_fmac_f32 v200, v220, v120
    v_fmac_f32 v201, v221, v121
    v_mfma_f32_16x16x32_bf16 v[172:175], a[52:55], v[84:87], v[172:175]
    ds_write_b128 v13, v[140:143] offset:0
    v_fmac_f32 v202, v222, v122
    v_mfma_f32_16x16x32_bf16 v[176:179], a[56:59], v[84:87], v[176:179]
    v_fmac_f32 v203, v223, v123
    s_waitcnt vmcnt(7)
    v_mfma_f32_16x16x32_bf16 v[160:163], a[100:103], v[88:91], v[160:163]
    ds_write_b128 v13, v[144:147] offset:64
    s_waitcnt lgkmcnt(5)
    v_fmac_f32 v204, v224, v124
    buffer_load_dwordx4 v[40:43], v6, s[44:47], s75 offen offset:2048 sc1
    v_mfma_f32_16x16x32_bf16 v[164:167], a[104:107], v[88:91], v[164:167]
    v_fmac_f32 v205, v225, v125
    v_fmac_f32 v206, v226, v126
    v_mfma_f32_16x16x32_bf16 v[168:171], a[108:111], v[88:91], v[168:171]
    ds_write_b128 v13, v[148:151] offset:128
    v_fmac_f32 v207, v227, v127
    v_mfma_f32_16x16x32_bf16 v[172:175], a[112:115], v[88:91], v[172:175]
    s_waitcnt lgkmcnt(5)
    v_fmac_f32 v208, v228, v128
    v_mfma_f32_16x16x32_bf16 v[176:179], a[116:119], v[88:91], v[176:179]
    ds_write_b128 v13, v[152:155] offset:192
    v_fmac_f32 v209, v229, v129
    s_waitcnt vmcnt(7)
    v_mfma_f32_16x16x32_bf16 v[160:163], a[160:163], v[92:95], v[160:163]
    v_fmac_f32 v210, v230, v130
    v_fmac_f32 v211, v231, v131
    buffer_load_dwordx4 v[44:47], v18, s[44:47], s75 offen offset:1024 sc1
    v_mfma_f32_16x16x32_bf16 v[164:167], a[164:167], v[92:95], v[164:167]
    ds_write_b128 v13, v[156:159] offset:256
    s_waitcnt lgkmcnt(6)
    v_fmac_f32 v212, v232, v132
    v_mfma_f32_16x16x32_bf16 v[168:171], a[168:171], v[92:95], v[168:171]
    v_fmac_f32 v213, v233, v133
    v_mfma_f32_16x16x32_bf16 v[172:175], a[172:175], v[92:95], v[172:175]
    v_fmac_f32 v214, v234, v134
    v_mfma_f32_16x16x32_bf16 v[176:179], a[176:179], v[92:95], v[176:179]
    v_fmac_f32 v215, v235, v135
    s_waitcnt lgkmcnt(5)
    v_fmac_f32 v216, v236, v136
    s_waitcnt vmcnt(7)
    v_mfma_f32_16x16x32_bf16 v[160:163], a[220:223], v[96:99], v[160:163]
    v_fmac_f32 v217, v237, v137
    s_waitcnt lgkmcnt(0)
    s_barrier
    ds_read_b128 v[140:143], v16 offset:5376
    buffer_load_dwordx4 v[48:51], v19, s[44:47], s75 offen offset:0 sc1
    v_mfma_f32_16x16x32_bf16 v[164:167], a[224:227], v[96:99], v[164:167]
    v_fmac_f32 v218, v238, v138
    ds_read_b128 v[144:147], v16 offset:5392
    v_mfma_f32_16x16x32_bf16 v[168:171], a[228:231], v[96:99], v[168:171]
    v_fmac_f32 v219, v239, v139
    ds_read_b128 v[148:151], v16 offset:5504
    v_mfma_f32_16x16x32_bf16 v[172:175], a[232:235], v[96:99], v[172:175]
    ds_read_b128 v[152:155], v16 offset:5520
    v_mfma_f32_16x16x32_bf16 v[176:179], a[236:239], v[96:99], v[176:179]
    ds_read_b128 v[156:159], v17 offset:5632
    s_waitcnt vmcnt(7)
    v_mfma_f32_16x16x32_bf16 v[180:183], a[80:83], v[100:103], v[180:183]
    buffer_load_dwordx4 v[52:55], v19, s[44:47], s75 offen offset:3072 sc1
    v_mfma_f32_16x16x32_bf16 v[184:187], a[84:87], v[100:103], v[184:187]
    v_mfma_f32_16x16x32_bf16 v[188:191], a[88:91], v[100:103], v[188:191]
    s_waitcnt lgkmcnt(4)
    v_fmac_f32 v200, v220, v140
    v_fmac_f32 v201, v221, v141
    v_mfma_f32_16x16x32_bf16 v[192:195], a[92:95], v[100:103], v[192:195]
    ds_write_b128 v14, v[160:163] offset:0
    v_fmac_f32 v202, v222, v142
    v_mfma_f32_16x16x32_bf16 v[196:199], a[96:99], v[100:103], v[196:199]
    v_fmac_f32 v203, v223, v143
    s_waitcnt vmcnt(7)
    v_mfma_f32_16x16x32_bf16 v[180:183], a[120:123], v[24:27], v[180:183]
    ds_write_b128 v14, v[164:167] offset:64
    s_waitcnt lgkmcnt(5)
    v_fmac_f32 v204, v224, v144
    v_mfma_f32_16x16x32_bf16 v[184:187], a[124:127], v[24:27], v[184:187]
    v_fmac_f32 v205, v225, v145
    v_fmac_f32 v206, v226, v146
    v_mfma_f32_16x16x32_bf16 v[188:191], a[128:131], v[24:27], v[188:191]
    ds_write_b128 v14, v[168:171] offset:128
    v_fmac_f32 v207, v227, v147
    v_mfma_f32_16x16x32_bf16 v[192:195], a[132:135], v[24:27], v[192:195]
    s_waitcnt lgkmcnt(5)
    v_fmac_f32 v208, v228, v148
    v_mfma_f32_16x16x32_bf16 v[196:199], a[136:139], v[24:27], v[196:199]
    ds_write_b128 v14, v[172:175] offset:192
    v_fmac_f32 v209, v229, v149
    s_waitcnt vmcnt(6)
    v_mfma_f32_16x16x32_bf16 v[180:183], a[140:143], v[28:31], v[180:183]
    v_fmac_f32 v210, v230, v150
    v_fmac_f32 v211, v231, v151
    v_mfma_f32_16x16x32_bf16 v[184:187], a[144:147], v[28:31], v[184:187]
    ds_write_b128 v14, v[176:179] offset:256
    s_waitcnt lgkmcnt(6)
    v_fmac_f32 v212, v232, v152
    v_mfma_f32_16x16x32_bf16 v[188:191], a[148:151], v[28:31], v[188:191]
    v_fmac_f32 v213, v233, v153
    v_mfma_f32_16x16x32_bf16 v[192:195], a[152:155], v[28:31], v[192:195]
    v_fmac_f32 v214, v234, v154
    v_mfma_f32_16x16x32_bf16 v[196:199], a[156:159], v[28:31], v[196:199]
    v_fmac_f32 v215, v235, v155
    s_waitcnt lgkmcnt(5)
    v_fmac_f32 v216, v236, v156
    s_waitcnt vmcnt(5)
    v_mfma_f32_16x16x32_bf16 v[180:183], a[180:183], v[32:35], v[180:183]
    v_fmac_f32 v217, v237, v157
    s_waitcnt lgkmcnt(0)
    s_barrier
    ds_read_b128 v[160:163], v16 offset:10752
    v_mfma_f32_16x16x32_bf16 v[184:187], a[184:187], v[32:35], v[184:187]
    v_fmac_f32 v218, v238, v158
    ds_read_b128 v[164:167], v16 offset:10768
    v_mfma_f32_16x16x32_bf16 v[188:191], a[188:191], v[32:35], v[188:191]
    v_fmac_f32 v219, v239, v159
    ds_read_b128 v[168:171], v16 offset:10880
    v_mfma_f32_16x16x32_bf16 v[192:195], a[192:195], v[32:35], v[192:195]
    ds_read_b128 v[172:175], v16 offset:10896
    v_mfma_f32_16x16x32_bf16 v[196:199], a[196:199], v[32:35], v[196:199]
    ds_read_b128 v[176:179], v17 offset:11008
    s_waitcnt vmcnt(4)
    v_mfma_f32_16x16x32_bf16 v[180:183], a[200:203], v[36:39], v[180:183]
    v_mfma_f32_16x16x32_bf16 v[184:187], a[204:207], v[36:39], v[184:187]
    v_mfma_f32_16x16x32_bf16 v[188:191], a[208:211], v[36:39], v[188:191]
    s_waitcnt lgkmcnt(4)
    v_fmac_f32 v200, v220, v160
    v_fmac_f32 v201, v221, v161
    v_mfma_f32_16x16x32_bf16 v[192:195], a[212:215], v[36:39], v[192:195]
    v_fmac_f32 v202, v222, v162
    v_mfma_f32_16x16x32_bf16 v[196:199], a[216:219], v[36:39], v[196:199]
    v_fmac_f32 v203, v223, v163
    s_waitcnt vmcnt(3)
    v_mfma_f32_16x16x32_bf16 v[180:183], a[40:43], v[40:43], v[180:183]
    s_waitcnt lgkmcnt(3)
    v_fmac_f32 v204, v224, v164
    s_waitcnt vmcnt(2)
    v_mfma_f32_16x16x32_bf16 v[180:183], a[100:103], v[44:47], v[180:183]
    v_fmac_f32 v205, v225, v165
    v_fmac_f32 v206, v226, v166
    s_waitcnt vmcnt(1)
    v_mfma_f32_16x16x32_bf16 v[180:183], a[160:163], v[48:51], v[180:183]
    v_fmac_f32 v207, v227, v167
    s_waitcnt vmcnt(0)
    v_mfma_f32_16x16x32_bf16 v[180:183], a[220:223], v[52:55], v[180:183]
    s_waitcnt lgkmcnt(2)
    v_fmac_f32 v208, v228, v168
    v_mfma_f32_16x16x32_bf16 v[184:187], a[44:47], v[40:43], v[184:187]
    v_fmac_f32 v209, v229, v169
    v_mfma_f32_16x16x32_bf16 v[184:187], a[104:107], v[44:47], v[184:187]
    v_fmac_f32 v210, v230, v170
    v_fmac_f32 v211, v231, v171
    v_mfma_f32_16x16x32_bf16 v[184:187], a[164:167], v[48:51], v[184:187]
    s_waitcnt lgkmcnt(1)
    v_fmac_f32 v212, v232, v172
    v_mfma_f32_16x16x32_bf16 v[184:187], a[224:227], v[52:55], v[184:187]
    v_fmac_f32 v213, v233, v173
    v_mfma_f32_16x16x32_bf16 v[188:191], a[48:51], v[40:43], v[188:191]
    v_fmac_f32 v214, v234, v174
    v_mfma_f32_16x16x32_bf16 v[188:191], a[108:111], v[44:47], v[188:191]
    v_fmac_f32 v215, v235, v175
    s_waitcnt lgkmcnt(0)
    v_fmac_f32 v216, v236, v176
    v_mfma_f32_16x16x32_bf16 v[188:191], a[168:171], v[48:51], v[188:191]
    v_fmac_f32 v217, v237, v177
    ds_write_b128 v15, v[180:183] offset:0
    v_mfma_f32_16x16x32_bf16 v[188:191], a[228:231], v[52:55], v[188:191]
    v_fmac_f32 v218, v238, v178
    v_mfma_f32_16x16x32_bf16 v[192:195], a[52:55], v[40:43], v[192:195]
    v_fmac_f32 v219, v239, v179
    v_mfma_f32_16x16x32_bf16 v[192:195], a[112:115], v[44:47], v[192:195]
    v_mfma_f32_16x16x32_bf16 v[192:195], a[172:175], v[48:51], v[192:195]
    ds_write_b128 v15, v[184:187] offset:64
    v_mfma_f32_16x16x32_bf16 v[192:195], a[232:235], v[52:55], v[192:195]
    v_mfma_f32_16x16x32_bf16 v[196:199], a[56:59], v[40:43], v[196:199]
    v_mfma_f32_16x16x32_bf16 v[196:199], a[116:119], v[44:47], v[196:199]
    v_mfma_f32_16x16x32_bf16 v[196:199], a[176:179], v[48:51], v[196:199]
    ds_write_b128 v15, v[188:191] offset:128
    v_mfma_f32_16x16x32_bf16 v[196:199], a[236:239], v[52:55], v[196:199]
    s_nop 2
    ds_write_b128 v15, v[192:195] offset:192
    s_nop 3
    ds_write_b128 v15, v[196:199] offset:256
    ds_read_b128 v[120:123], v16 offset:16128
    ds_read_b128 v[124:127], v16 offset:16144
    ds_read_b128 v[128:131], v16 offset:16256
    ds_read_b128 v[132:135], v16 offset:16272
    ds_read_b128 v[136:139], v17 offset:16384
    s_waitcnt lgkmcnt(4)
    v_pk_fma_f32 v[120:121], v[120:121], v[220:221], v[200:201]
    v_cvt_pk_bf16_f32 v140, v120, v121
    v_pk_fma_f32 v[122:123], v[122:123], v[222:223], v[202:203]
    v_cvt_pk_bf16_f32 v141, v122, v123
    s_waitcnt lgkmcnt(3)
    v_pk_fma_f32 v[124:125], v[124:125], v[224:225], v[204:205]
    v_cvt_pk_bf16_f32 v142, v124, v125
    v_pk_fma_f32 v[126:127], v[126:127], v[226:227], v[206:207]
    v_cvt_pk_bf16_f32 v143, v126, v127
    buffer_store_dwordx4 v[140:143], v248, s[40:43], 0 offen
    s_waitcnt lgkmcnt(2)
    v_pk_fma_f32 v[128:129], v[128:129], v[228:229], v[208:209]
    v_cvt_pk_bf16_f32 v144, v128, v129
    v_pk_fma_f32 v[130:131], v[130:131], v[230:231], v[210:211]
    v_cvt_pk_bf16_f32 v145, v130, v131
    s_waitcnt lgkmcnt(1)
    v_pk_fma_f32 v[132:133], v[132:133], v[232:233], v[212:213]
    v_cvt_pk_bf16_f32 v146, v132, v133
    v_pk_fma_f32 v[134:135], v[134:135], v[234:235], v[214:215]
    v_cvt_pk_bf16_f32 v147, v134, v135
    buffer_store_dwordx4 v[144:147], v248, s[40:43], 0 offen offset:64
    s_waitcnt lgkmcnt(0)
    v_pk_fma_f32 v[136:137], v[136:137], v[236:237], v[216:217]
    v_cvt_pk_bf16_f32 v148, v136, v137
    v_pk_fma_f32 v[138:139], v[138:139], v[238:239], v[218:219]
    v_cvt_pk_bf16_f32 v149, v138, v139
    buffer_store_dwordx2 v[148:149], v249, s[40:43], 0 offen offset:128
L_end:
    s_endpgm
L_retry_mod1:
    s_sub_u32 s96, s96, 1
    s_cmp_lt_i32 s96, 0
    s_cbranch_scc1 L_ok_mod1
    buffer_load_dwordx4 v[24:27], v7, s[44:47], s76 offen sc1
    buffer_load_dwordx4 v[28:31], v7, s[44:47], s77 offen sc1
    buffer_load_dwordx4 v[32:35], v7, s[44:47], s78 offen sc1
    buffer_load_dwordx4 v[36:39], v7, s[44:47], s79 offen sc1
    buffer_load_dwordx4 v[40:43], v200, s[44:47], s76 offen sc1
    s_waitcnt vmcnt(0)
    s_branch L_chk_mod1
L_retry_mod2:
    s_sub_u32 s96, s96, 1
    s_cmp_lt_i32 s96, 0
    s_cbranch_scc1 L_ok_mod2
    s_mov_b32 s93, 70656
    buffer_load_dwordx4 v[160:163], v7, s[44:47], s93 offen sc1
    buffer_load_dwordx4 v[176:179], v246, s[44:47], s93 offen sc1
    s_mov_b32 s93, 86016
    buffer_load_dwordx4 v[164:167], v7, s[44:47], s93 offen sc1
    buffer_load_dwordx4 v[180:183], v246, s[44:47], s93 offen sc1
    s_mov_b32 s93, 101376
    buffer_load_dwordx4 v[168:171], v7, s[44:47], s93 offen sc1
    buffer_load_dwordx4 v[184:187], v246, s[44:47], s93 offen sc1
    s_mov_b32 s93, 116736
    buffer_load_dwordx4 v[172:175], v7, s[44:47], s93 offen sc1
    buffer_load_dwordx4 v[188:191], v246, s[44:47], s93 offen sc1
    s_waitcnt vmcnt(0)
    s_branch L_chk_mod2
L_retry_t:
    s_sub_u32 s96, s96, 1
    s_cmp_lt_i32 s96, 0
    s_cbranch_scc1 L_ok_t
    v_cmp_ne_u32 vcc, s50, v27
    s_cbranch_vccz L_m1
    s_mov_b64 exec, vcc
    buffer_load_dwordx4 v[24:27], v148, s[44:47], s76 offen sc1
    s_mov_b64 exec, -1
L_m1:
    v_cmp_ne_u32 vcc, s50, v31
    s_cbranch_vccz L_m2
    s_mov_b64 exec, vcc
    buffer_load_dwordx4 v[28:31], v148, s[44:47], s77 offen sc1
    s_mov_b64 exec, -1
L_m2:
    v_cmp_ne_u32 vcc, s50, v35
    s_cbranch_vccz L_m3
    s_mov_b64 exec, vcc
    buffer_load_dwordx4 v[32:35], v148, s[44:47], s78 offen sc1
    s_mov_b64 exec, -1
L_m3:
    v_cmp_ne_u32 vcc, s50, v39
    s_cbranch_vccz L_m4
    s_mov_b64 exec, vcc
    buffer_load_dwordx4 v[36:39], v148, s[44:47], s79 offen sc1
    s_mov_b64 exec, -1
L_m4:
    s_waitcnt vmcnt(0)
    s_branch L_chk_t
L_retry_tp:
    s_sub_u32 s96, s96, 1
    s_cmp_lt_i32 s96, 0
    s_cbranch_scc1 L_ok_tp
    v_cmp_ne_u32 vcc, s50, v27
    s_cbranch_vccz L_m5
    s_mov_b64 exec, vcc
    buffer_load_dwordx4 v[24:27], v236, s[44:47], s76 offen sc1
    s_mov_b64 exec, -1
L_m5:
    v_cmp_ne_u32 vcc, s50, v31
    s_cbranch_vccz L_m6
    s_mov_b64 exec, vcc
    buffer_load_dwordx4 v[28:31], v236, s[44:47], s77 offen sc1
    s_mov_b64 exec, -1
L_m6:
    v_cmp_ne_u32 vcc, s50, v35
    s_cbranch_vccz L_m7
    s_mov_b64 exec, vcc
    buffer_load_dwordx4 v[32:35], v237, s[44:47], s78 offen sc1
    s_mov_b64 exec, -1
L_m7:
    v_cmp_ne_u32 vcc, s50, v39
    s_cbranch_vccz L_m8
    s_mov_b64 exec, vcc
    buffer_load_dwordx4 v[36:39], v237, s[44:47], s79 offen sc1
    s_mov_b64 exec, -1
L_m8:
    s_waitcnt vmcnt(0)
    s_branch L_chk_tp
L_slow_pub0:
    buffer_wbl2 sc1
    s_waitcnt vmcnt(0)
    buffer_store_dword v253, v252, s[44:47], s92 offen offset:0 sc1
    s_branch L_join_pub0
L_retry_fl0:
    s_sub_u32 s96, s96, 1
    s_cmp_lt_i32 s96, 0
    s_cbranch_scc1 L_ok_fl0
    buffer_load_dword v251, v250, s[44:47], s92 offen offset:0 sc1
    s_waitcnt vmcnt(0)
    s_branch L_chk_fl0
L_slow_acq0:
    buffer_inv sc1
    s_waitcnt vmcnt(0)
    s_branch L_join_acq0
L_slow_pub1:
    buffer_store_dword v253, v252, s[44:47], s92 offen offset:256 sc1
    s_branch L_join_pub1
L_retry_fl1:
    s_sub_u32 s96, s96, 1
    s_cmp_lt_i32 s96, 0
    s_cbranch_scc1 L_ok_fl1
    buffer_load_dword v251, v250, s[44:47], s92 offen offset:256 sc1
    s_waitcnt vmcnt(0)
    s_branch L_chk_fl1
L_slow_pub2:
    buffer_store_dword v253, v252, s[44:47], s92 offen offset:512 sc1
    s_branch L_join_pub2
L_retry_fl2:
    s_sub_u32 s96, s96, 1
    s_cmp_lt_i32 s96, 0
    s_cbranch_scc1 L_ok_fl2
    buffer_load_dword v251, v250, s[44:47], s92 offen offset:512 sc1
    s_waitcnt vmcnt(0)
    s_branch L_chk_fl2
L_last:
    s_endpgm
.section .rodata,"a"
.p2align 6
.amdhsa_kernel adaLN_cond__spectral_gfnet__mixer_channel_mlp__prompt_kernel
  .amdhsa_next_free_vgpr 512
  .amdhsa_next_free_sgpr 102
  .amdhsa_accum_offset 256
  .amdhsa_group_segment_fixed_size 0
  .amdhsa_kernarg_size 104
  .amdhsa_user_sgpr_count 2
  .amdhsa_user_sgpr_kernarg_segment_ptr 1
  .amdhsa_system_sgpr_workgroup_id_x 1
.end_amdhsa_kernel
```
